```python
import torch

def _softmax(x, axis=-1):
    return torch.softmax(x, dim=axis)
def _gelu(x):
    return torch.nn.functional.gelu(x, approximate="tanh")
def _silu(x):
    return torch.nn.functional.silu(x)
def _sigmoid(x):
    return torch.sigmoid(x)
def _layernorm(x, axis=-1, eps=1e-5):
    m = x.mean(dim=axis, keepdim=True)
    v = x.var(dim=axis, keepdim=True, unbiased=False)
    return (x - m) / torch.sqrt(v + eps)
def _scatter_add(tgt, idx, src, axis=0):
    return tgt.clone().index_add_(axis, idx, src)
def _segment_sum(src, seg, n):
    out = torch.zeros((n,) + src.shape[1:], dtype=src.dtype)
    return out.index_add_(0, seg, src)
def _pad(x, pw):
    flat = tuple(v for pair in reversed(pw) for v in pair)
    return torch.nn.functional.pad(x, flat)

kernel_name = 'sequential_preLN__gqa_block_cached__dense_activation_silu__decode'

def setup_inputs():

    _w = (lambda a: (lambda t: t.to(torch.bfloat16) if t.is_floating_point() else t)(torch.as_tensor(a)))
    def _A_setup():
        B, Sq, D = 2, 1, 1024
        Hq, Hkv, Sk, Dh = 32, 4, 16384, 128
        assert Hq % Hkv == 0, (Hq, Hkv)
        return {
            "x": _w((lambda *s: torch.randn(*s, dtype=torch.bfloat16) * 0.1)(B, Sq, D)),
            "k_cache": _w((lambda *s: torch.randn(*s, dtype=torch.bfloat16) * 1.6)(B, Hkv, Sk, Dh)),
            "v_cache": _w((lambda *s: torch.randn(*s, dtype=torch.bfloat16) * 1.6)(B, Hkv, Sk, Dh)),
            "wq": _w((lambda *s: torch.randn(*s, dtype=torch.bfloat16) * 1.6)(D, Hq * Dh) * (D ** -0.5)),
            "wo": _w((lambda *s: torch.randn(*s, dtype=torch.bfloat16) * 1.6)(Hq * Dh, D) * ((Hq * Dh) ** -0.5)),
        }
    _A_in = _A_setup()

    def _B_setup():
        B, S, D, F = 2, 1, 1024, 3584
        return {
            "x": _w((lambda *s: torch.randn(*s, dtype=torch.bfloat16) * 0.1)(B, S, D)),
            "w1": _w((lambda *s: torch.randn(*s, dtype=torch.bfloat16) * 3.2)(D, F) * (D ** -0.5)),
            "w2": _w((lambda *s: torch.randn(*s, dtype=torch.bfloat16) * 3.2)(F, D) * (F ** -0.5)),
        }
    _B_in = _B_setup()

    return {
        "A_x": _A_in["x"],
        "A_k_cache": _A_in["k_cache"],
        "A_v_cache": _A_in["v_cache"],
        "A_wq": _A_in["wq"],
        "A_wo": _A_in["wo"],
        "B_x": _B_in["x"],
        "B_w1": _B_in["w1"],
        "B_w2": _B_in["w2"],
    }

def reference(A_x, A_k_cache, A_v_cache, A_wq, A_wo, B_x, B_w1, B_w2):
    def _A_ref(x, k_cache, v_cache, wq, wo):
        B, Sq, D = x.shape
        Hq, Dh = 32, 128
        Hkv = k_cache.shape[1]
        rep = Hq // Hkv
        q = (lambda x, *d: x.permute(*d))((x @ wq).reshape(B, Sq, Hq, Dh), 0, 2, 1, 3)
        k = (lambda x, n, axis: torch.repeat_interleave(x, n, dim=axis))(k_cache, rep, axis=1)
        v = (lambda x, n, axis: torch.repeat_interleave(x, n, dim=axis))(v_cache, rep, axis=1)
        scores = torch.einsum("bhqd,bhkd->bhqk", q, k) * (Dh ** -0.5)
        p = _softmax(scores, axis=-1)
        o = torch.einsum("bhqk,bhkd->bhqd", p, v)
        return (lambda x, *d: x.permute(*d))(o, 0, 2, 1, 3).reshape(B, Sq, Hq * Dh) @ wo

    def _B_ref(x, w1, w2):
        h = torch.einsum("bsd,df->bsf", x, w1)
        h = _silu(h)
        out = torch.einsum("bsf,fd->bsd", h, w2)
        return out

    x = A_x
    h = x + _A_ref(_layernorm(x, axis=-1), A_k_cache, A_v_cache, A_wq, A_wo)
    h2 = h + _B_ref(_layernorm(h, axis=-1), B_w1, B_w2)
    return h2
```

```asm
; @launch grid=(256,1,1) block=(512,1,1) lds=26624
.amdgcn_target "amdgcn-amd-amdhsa--gfx950"
.text
.globl sequential_preLN__gqa_block_cached__dense_activation_silu__decode_kernel
.p2align 8
.type sequential_preLN__gqa_block_cached__dense_activation_silu__decode_kernel,@function
sequential_preLN__gqa_block_cached__dense_activation_silu__decode_kernel:
s_cmp_ge_u32 s2, 256
s_cbranch_scc1 L_end
s_load_dwordx16 s[16:31], s[0:1], 0
s_load_dwordx4 s[32:35], s[0:1], 64
s_load_dwordx2 s[36:37], s[0:1], 80
s_getpc_b64 s[4:5]
L_pc:
v_lshrrev_b32 v8, 6, v0
v_and_b32 v1, 63, v0
s_mov_b32 s56, s4
s_mov_b32 s57, s5
s_mov_b32 s58, L_code_end-L_pc
s_mov_b32 s59, 0x20000
v_readfirstlane_b32 s3, v8
v_lshlrev_b32 v9, 6, v0
buffer_load_dword v255, v9, s[56:59], 0 offen
v_lshlrev_b32 v9, 2, v0
v_mov_b32 v8, 0
ds_write_b32 v9, v8
s_mov_b32 s84, 0xff00ff00
s_mov_b32 s85, 0xff00ff00
v_mov_b32 v3, 0
s_and_b32 s91, s2, 7
s_lshr_b32 s90, s2, 3
s_lshr_b32 s88, s91, 2
s_and_b32 s89, s91, 3
s_cmp_ge_u32 s3, 4
s_cbranch_scc1 L_kw
v_and_b32 v16, 15, v1
v_lshrrev_b32 v17, 4, v1
v_lshlrev_b32 v18, 6, v1
s_and_b32 s60, s2, 3
s_lshl_b32 s60, s60, 8
s_lshl_b32 s61, s3, 6
s_add_u32 s60, s60, s61
v_lshrrev_b32 v19, 3, v16
v_lshlrev_b32 v20, 11, v19
v_lshlrev_b32 v21, 5, v17
v_add_u32 v20, v20, v21
s_lshl_b32 s61, s60, 1
v_add_u32 v20, s61, v20
s_lshr_b32 s62, s2, 3
s_mul_i32 s64, s62, 37
s_lshr_b32 s64, s64, 8
s_mul_i32 s65, s64, 7
s_sub_u32 s100, s62, s65
s_lshl_b32 s64, s64, 3
s_add_u32 s96, s64, s91
v_lshlrev_b32 v21, 4, v17
v_add_u32 v21, v21, v19
v_add_u32 v21, s60, v21
v_lshlrev_b32 v21, 13, v21
v_and_b32 v22, 7, v16
v_lshlrev_b32 v22, 4, v22
v_add_u32 v21, v21, v22
s_lshr_b32 s62, s2, 2
s_lshl_b32 s62, s62, 7
v_add_u32 v21, s62, v21
s_waitcnt lgkmcnt(0)
s_mov_b32 s52, s36
s_mov_b32 s53, s37
s_mov_b32 s54, 0x4a0000
s_mov_b32 s55, 0x20000
s_mov_b32 s40, s16
s_mov_b32 s41, s17
s_mov_b32 s42, 0x1000
s_mov_b32 s43, 0x20000
s_mov_b32 s44, s22
s_mov_b32 s45, s23
s_mov_b32 s46, 0x800000
s_mov_b32 s47, 0x20000
buffer_load_dwordx4 v[128:131], v18, s[40:43], 0 offen offset:0
buffer_load_dwordx4 v[132:135], v18, s[40:43], 0 offen offset:16
buffer_load_dwordx4 v[136:139], v18, s[40:43], 0 offen offset:32
buffer_load_dwordx4 v[140:143], v18, s[40:43], 0 offen offset:48
buffer_load_dwordx4 v[144:147], v20, s[40:43], 0 offen offset:0
buffer_load_dwordx4 v[148:151], v20, s[40:43], 0 offen offset:16
v_mov_b32 v9, 0
buffer_load_dword v2, v9, s[52:55], 0 offen sc1
s_mov_b32 s63, 0
buffer_load_dwordx4 v[32:35], v21, s[44:47], s63 offen nt
s_mov_b32 s63, 16384
buffer_load_dwordx4 v[36:39], v21, s[44:47], s63 offen nt
s_mov_b32 s63, 32768
buffer_load_dwordx4 v[40:43], v21, s[44:47], s63 offen nt
s_mov_b32 s63, 49152
buffer_load_dwordx4 v[44:47], v21, s[44:47], s63 offen nt
s_mov_b32 s63, 65536
buffer_load_dwordx4 v[48:51], v21, s[44:47], s63 offen nt
s_mov_b32 s63, 81920
buffer_load_dwordx4 v[52:55], v21, s[44:47], s63 offen nt
s_mov_b32 s63, 98304
buffer_load_dwordx4 v[56:59], v21, s[44:47], s63 offen nt
s_mov_b32 s63, 114688
buffer_load_dwordx4 v[60:63], v21, s[44:47], s63 offen nt
s_barrier
v_and_b32 v17, 7, v1
v_and_b32 v18, 1, v1
v_cmp_eq_u32 s[60:61], 1, v18
v_lshrrev_b32 v17, 1, v17
v_mov_b32 v18, 0xc0c0100
v_mov_b32 v16, 0x1000c0c
v_cndmask_b32 v18, v18, v16, s[60:61]
v_cmp_eq_u32 vcc, 0, v17
v_mov_b32 v16, 0x0c0c0c0c
s_nop 0
v_cndmask_b32 v8, v16, v18, vcc
v_cmp_eq_u32 vcc, 1, v17
v_mov_b32 v16, 0x0c0c0c0c
s_nop 0
v_cndmask_b32 v10, v16, v18, vcc
v_cmp_eq_u32 vcc, 2, v17
v_mov_b32 v16, 0x0c0c0c0c
s_nop 0
v_cndmask_b32 v12, v16, v18, vcc
v_cmp_eq_u32 vcc, 3, v17
v_mov_b32 v16, 0x0c0c0c0c
s_nop 0
v_cndmask_b32 v14, v16, v18, vcc
v_mov_b32 v18, 0xc0c0302
v_mov_b32 v16, 0x3020c0c
v_cndmask_b32 v18, v18, v16, s[60:61]
v_cmp_eq_u32 vcc, 0, v17
v_mov_b32 v16, 0x0c0c0c0c
s_nop 0
v_cndmask_b32 v9, v16, v18, vcc
v_cmp_eq_u32 vcc, 1, v17
v_mov_b32 v16, 0x0c0c0c0c
s_nop 0
v_cndmask_b32 v11, v16, v18, vcc
v_cmp_eq_u32 vcc, 2, v17
v_mov_b32 v16, 0x0c0c0c0c
s_nop 0
v_cndmask_b32 v13, v16, v18, vcc
v_cmp_eq_u32 vcc, 3, v17
v_mov_b32 v16, 0x0c0c0c0c
s_nop 0
v_cndmask_b32 v15, v16, v18, vcc
v_and_b32 v16, 15, v1
v_lshrrev_b32 v17, 4, v1
s_waitcnt vmcnt(11)
v_lshlrev_b32 v152, 16, v128
v_and_b32 v153, 0xffff0000, v128
v_lshlrev_b32 v154, 16, v129
v_and_b32 v155, 0xffff0000, v129
v_lshlrev_b32 v156, 16, v130
v_and_b32 v157, 0xffff0000, v130
v_lshlrev_b32 v158, 16, v131
v_and_b32 v159, 0xffff0000, v131
v_lshlrev_b32 v160, 16, v132
v_and_b32 v161, 0xffff0000, v132
v_lshlrev_b32 v162, 16, v133
v_and_b32 v163, 0xffff0000, v133
v_lshlrev_b32 v164, 16, v134
v_and_b32 v165, 0xffff0000, v134
v_lshlrev_b32 v166, 16, v135
v_and_b32 v167, 0xffff0000, v135
v_lshlrev_b32 v168, 16, v136
v_and_b32 v169, 0xffff0000, v136
v_lshlrev_b32 v170, 16, v137
v_and_b32 v171, 0xffff0000, v137
v_lshlrev_b32 v172, 16, v138
v_and_b32 v173, 0xffff0000, v138
v_lshlrev_b32 v174, 16, v139
v_and_b32 v175, 0xffff0000, v139
v_lshlrev_b32 v176, 16, v140
v_and_b32 v177, 0xffff0000, v140
v_lshlrev_b32 v178, 16, v141
v_and_b32 v179, 0xffff0000, v141
v_lshlrev_b32 v180, 16, v142
v_and_b32 v181, 0xffff0000, v142
v_lshlrev_b32 v182, 16, v143
v_and_b32 v183, 0xffff0000, v143
v_add_f32 v22, v152, v153
v_add_f32 v23, v154, v155
v_add_f32 v22, v22, v23
v_add_f32 v23, v156, v157
v_add_f32 v22, v22, v23
v_add_f32 v23, v158, v159
v_add_f32 v22, v22, v23
v_add_f32 v23, v160, v161
v_add_f32 v22, v22, v23
v_add_f32 v23, v162, v163
v_add_f32 v22, v22, v23
v_add_f32 v23, v164, v165
v_add_f32 v22, v22, v23
v_add_f32 v23, v166, v167
v_add_f32 v22, v22, v23
v_add_f32 v23, v168, v169
v_add_f32 v22, v22, v23
v_add_f32 v23, v170, v171
v_add_f32 v22, v22, v23
v_add_f32 v23, v172, v173
v_add_f32 v22, v22, v23
v_add_f32 v23, v174, v175
v_add_f32 v22, v22, v23
v_add_f32 v23, v176, v177
v_add_f32 v22, v22, v23
v_add_f32 v23, v178, v179
v_add_f32 v22, v22, v23
v_add_f32 v23, v180, v181
v_add_f32 v22, v22, v23
v_add_f32 v23, v182, v183
v_add_f32 v22, v22, v23
s_nop 1
v_add_f32_dpp v22, v22, v22 row_ror:8 row_mask:0xf bank_mask:0xf
s_nop 1
v_add_f32_dpp v22, v22, v22 row_ror:4 row_mask:0xf bank_mask:0xf
s_nop 1
v_add_f32_dpp v22, v22, v22 row_ror:2 row_mask:0xf bank_mask:0xf
s_nop 1
v_add_f32_dpp v22, v22, v22 row_ror:1 row_mask:0xf bank_mask:0xf
v_mov_b32 v23, v22
s_nop 1
v_permlane16_swap_b32 v22, v23
v_add_f32 v22, v22, v23
v_mul_f32 v22, 0x3a800000, v22
v_sub_f32 v152, v152, v22
v_sub_f32 v153, v153, v22
v_sub_f32 v154, v154, v22
v_sub_f32 v155, v155, v22
v_sub_f32 v156, v156, v22
v_sub_f32 v157, v157, v22
v_sub_f32 v158, v158, v22
v_sub_f32 v159, v159, v22
v_sub_f32 v160, v160, v22
v_sub_f32 v161, v161, v22
v_sub_f32 v162, v162, v22
v_sub_f32 v163, v163, v22
v_sub_f32 v164, v164, v22
v_sub_f32 v165, v165, v22
v_sub_f32 v166, v166, v22
v_sub_f32 v167, v167, v22
v_sub_f32 v168, v168, v22
v_sub_f32 v169, v169, v22
v_sub_f32 v170, v170, v22
v_sub_f32 v171, v171, v22
v_sub_f32 v172, v172, v22
v_sub_f32 v173, v173, v22
v_sub_f32 v174, v174, v22
v_sub_f32 v175, v175, v22
v_sub_f32 v176, v176, v22
v_sub_f32 v177, v177, v22
v_sub_f32 v178, v178, v22
v_sub_f32 v179, v179, v22
v_sub_f32 v180, v180, v22
v_sub_f32 v181, v181, v22
v_sub_f32 v182, v182, v22
v_sub_f32 v183, v183, v22
v_mul_f32 v24, v152, v152
v_fmac_f32 v24, v153, v153
v_fmac_f32 v24, v154, v154
v_fmac_f32 v24, v155, v155
v_fmac_f32 v24, v156, v156
v_fmac_f32 v24, v157, v157
v_fmac_f32 v24, v158, v158
v_fmac_f32 v24, v159, v159
v_fmac_f32 v24, v160, v160
v_fmac_f32 v24, v161, v161
v_fmac_f32 v24, v162, v162
v_fmac_f32 v24, v163, v163
v_fmac_f32 v24, v164, v164
v_fmac_f32 v24, v165, v165
v_fmac_f32 v24, v166, v166
v_fmac_f32 v24, v167, v167
v_fmac_f32 v24, v168, v168
v_fmac_f32 v24, v169, v169
v_fmac_f32 v24, v170, v170
v_fmac_f32 v24, v171, v171
v_fmac_f32 v24, v172, v172
v_fmac_f32 v24, v173, v173
v_fmac_f32 v24, v174, v174
v_fmac_f32 v24, v175, v175
v_fmac_f32 v24, v176, v176
v_fmac_f32 v24, v177, v177
v_fmac_f32 v24, v178, v178
v_fmac_f32 v24, v179, v179
v_fmac_f32 v24, v180, v180
v_fmac_f32 v24, v181, v181
v_fmac_f32 v24, v182, v182
v_fmac_f32 v24, v183, v183
s_nop 1
v_add_f32_dpp v24, v24, v24 row_ror:8 row_mask:0xf bank_mask:0xf
s_nop 1
v_add_f32_dpp v24, v24, v24 row_ror:4 row_mask:0xf bank_mask:0xf
s_nop 1
v_add_f32_dpp v24, v24, v24 row_ror:2 row_mask:0xf bank_mask:0xf
s_nop 1
v_add_f32_dpp v24, v24, v24 row_ror:1 row_mask:0xf bank_mask:0xf
v_mov_b32 v23, v24
s_nop 1
v_permlane16_swap_b32 v24, v23
v_add_f32 v24, v24, v23
v_mul_f32 v24, 0x3a800000, v24
v_readlane_b32 s81, v22, 0
v_readlane_b32 s82, v22, 32
v_lshrrev_b32 v23, 5, v1
v_lshlrev_b32 v23, 2, v23
ds_write_b32 v23, v22 offset:25600
v_cvt_pk_bf16_f32 v22, v22, v22
v_lshlrev_b32 v22, 16, v22
v_cvt_pk_bf16_f32 v24, v24, v24
v_lshlrev_b32 v24, 16, v24
v_add_f32 v24, 0x3727c5ac, v24
v_cvt_pk_bf16_f32 v24, v24, v24
v_lshlrev_b32 v24, 16, v24
v_sqrt_f32 v25, v24
v_rcp_f32 v26, v25
v_fma_f32 v27, -v25, v25, v24
v_mul_f32 v26, 0.5, v26
v_fma_f32 v25, v27, v26, v25
v_cvt_pk_bf16_f32 v25, v25, v25
v_lshlrev_b32 v25, 16, v25
v_readlane_b32 s60, v22, 0
v_readlane_b32 s61, v22, 32
v_readlane_b32 s62, v25, 0
v_readlane_b32 s63, v25, 32
v_mov_b32 v22, s60
v_mov_b32 v23, s61
v_cndmask_b32 v22, v22, v23, s[84:85]
v_mov_b32 v24, s62
v_mov_b32 v23, s63
v_cndmask_b32 v24, v24, v23, s[84:85]
v_rcp_f32 v25, v24
s_waitcnt vmcnt(8)
v_readfirstlane_b32 s98, v2
s_add_u32 s80, s98, 1
s_and_b32 s60, s80, 1023
v_mov_b32 v4, s60
s_mul_i32 s60, s80, 3
s_lshr_b32 s61, s80, 10
s_add_u32 s60, s60, s61
s_and_b32 s60, s60, 1023
v_mov_b32 v5, s60
s_mul_i32 s60, s80, 5
s_lshr_b32 s61, s80, 20
s_add_u32 s60, s60, s61
s_and_b32 s60, s60, 1023
v_mov_b32 v6, s60
s_mul_i32 s60, s80, 7
s_lshr_b32 s61, s80, 15
s_mul_i32 s61, s61, 3
s_add_u32 s60, s60, s61
s_and_b32 s60, s60, 1023
v_mov_b32 v7, s60
s_mov_b32 s87, 1023
v_lshlrev_b32 v26, 16, v144
v_and_b32 v27, 0xffff0000, v144
v_sub_f32 v26, v26, v22
v_sub_f32 v27, v27, v22
v_cvt_pk_bf16_f32 v28, v26, v27
v_lshlrev_b32 v26, 16, v28
v_and_b32 v27, 0xffff0000, v28
v_mul_f32 v28, v26, v25
v_fma_f32 v29, -v28, v24, v26
v_fma_f32 v26, v29, v25, v28
v_mul_f32 v28, v27, v25
v_fma_f32 v29, -v28, v24, v27
v_fma_f32 v27, v29, v25, v28
v_cvt_pk_bf16_f32 v144, v26, v27
v_lshlrev_b32 v26, 16, v145
v_and_b32 v27, 0xffff0000, v145
v_sub_f32 v26, v26, v22
v_sub_f32 v27, v27, v22
v_cvt_pk_bf16_f32 v28, v26, v27
v_lshlrev_b32 v26, 16, v28
v_and_b32 v27, 0xffff0000, v28
v_mul_f32 v28, v26, v25
v_fma_f32 v29, -v28, v24, v26
v_fma_f32 v26, v29, v25, v28
v_mul_f32 v28, v27, v25
v_fma_f32 v29, -v28, v24, v27
v_fma_f32 v27, v29, v25, v28
v_cvt_pk_bf16_f32 v145, v26, v27
v_lshlrev_b32 v26, 16, v146
v_and_b32 v27, 0xffff0000, v146
v_sub_f32 v26, v26, v22
v_sub_f32 v27, v27, v22
v_cvt_pk_bf16_f32 v28, v26, v27
v_lshlrev_b32 v26, 16, v28
v_and_b32 v27, 0xffff0000, v28
v_mul_f32 v28, v26, v25
v_fma_f32 v29, -v28, v24, v26
v_fma_f32 v26, v29, v25, v28
v_mul_f32 v28, v27, v25
v_fma_f32 v29, -v28, v24, v27
v_fma_f32 v27, v29, v25, v28
v_cvt_pk_bf16_f32 v146, v26, v27
v_lshlrev_b32 v26, 16, v147
v_and_b32 v27, 0xffff0000, v147
v_sub_f32 v26, v26, v22
v_sub_f32 v27, v27, v22
v_cvt_pk_bf16_f32 v28, v26, v27
v_lshlrev_b32 v26, 16, v28
v_and_b32 v27, 0xffff0000, v28
v_mul_f32 v28, v26, v25
v_fma_f32 v29, -v28, v24, v26
v_fma_f32 v26, v29, v25, v28
v_mul_f32 v28, v27, v25
v_fma_f32 v29, -v28, v24, v27
v_fma_f32 v27, v29, v25, v28
v_cvt_pk_bf16_f32 v147, v26, v27
v_lshlrev_b32 v26, 16, v148
v_and_b32 v27, 0xffff0000, v148
v_sub_f32 v26, v26, v22
v_sub_f32 v27, v27, v22
v_cvt_pk_bf16_f32 v28, v26, v27
v_lshlrev_b32 v26, 16, v28
v_and_b32 v27, 0xffff0000, v28
v_mul_f32 v28, v26, v25
v_fma_f32 v29, -v28, v24, v26
v_fma_f32 v26, v29, v25, v28
v_mul_f32 v28, v27, v25
v_fma_f32 v29, -v28, v24, v27
v_fma_f32 v27, v29, v25, v28
v_cvt_pk_bf16_f32 v148, v26, v27
v_lshlrev_b32 v26, 16, v149
v_and_b32 v27, 0xffff0000, v149
v_sub_f32 v26, v26, v22
v_sub_f32 v27, v27, v22
v_cvt_pk_bf16_f32 v28, v26, v27
v_lshlrev_b32 v26, 16, v28
v_and_b32 v27, 0xffff0000, v28
v_mul_f32 v28, v26, v25
v_fma_f32 v29, -v28, v24, v26
v_fma_f32 v26, v29, v25, v28
v_mul_f32 v28, v27, v25
v_fma_f32 v29, -v28, v24, v27
v_fma_f32 v27, v29, v25, v28
v_cvt_pk_bf16_f32 v149, v26, v27
v_lshlrev_b32 v26, 16, v150
v_and_b32 v27, 0xffff0000, v150
v_sub_f32 v26, v26, v22
v_sub_f32 v27, v27, v22
v_cvt_pk_bf16_f32 v28, v26, v27
v_lshlrev_b32 v26, 16, v28
v_and_b32 v27, 0xffff0000, v28
v_mul_f32 v28, v26, v25
v_fma_f32 v29, -v28, v24, v26
v_fma_f32 v26, v29, v25, v28
v_mul_f32 v28, v27, v25
v_fma_f32 v29, -v28, v24, v27
v_fma_f32 v27, v29, v25, v28
v_cvt_pk_bf16_f32 v150, v26, v27
v_lshlrev_b32 v26, 16, v151
v_and_b32 v27, 0xffff0000, v151
v_sub_f32 v26, v26, v22
v_sub_f32 v27, v27, v22
v_cvt_pk_bf16_f32 v28, v26, v27
v_lshlrev_b32 v26, 16, v28
v_and_b32 v27, 0xffff0000, v28
v_mul_f32 v28, v26, v25
v_fma_f32 v29, -v28, v24, v26
v_fma_f32 v26, v29, v25, v28
v_mul_f32 v28, v27, v25
v_fma_f32 v29, -v28, v24, v27
v_fma_f32 v27, v29, v25, v28
v_cvt_pk_bf16_f32 v151, v26, v27
v_mov_b32 v64, 0
v_mov_b32 v65, 0
v_mov_b32 v66, 0
v_mov_b32 v67, 0
v_mov_b32 v68, 0
v_mov_b32 v69, 0
v_mov_b32 v70, 0
v_mov_b32 v71, 0
s_waitcnt vmcnt(0)
v_perm_b32 v96, v144, v144, v8
v_perm_b32 v97, v144, v144, v10
v_perm_b32 v98, v144, v144, v12
v_perm_b32 v99, v144, v144, v14
v_perm_b32 v100, v144, v144, v9
v_perm_b32 v101, v144, v144, v11
v_perm_b32 v102, v144, v144, v13
v_perm_b32 v103, v144, v144, v15
v_mfma_f32_16x16x32_bf16 v[64:67], v[96:99], v[32:35], v[64:67]
s_nop 0
v_mfma_f32_16x16x32_bf16 v[68:71], v[100:103], v[32:35], v[68:71]
v_perm_b32 v104, v145, v145, v8
v_perm_b32 v105, v145, v145, v10
v_perm_b32 v106, v145, v145, v12
v_perm_b32 v107, v145, v145, v14
v_perm_b32 v108, v145, v145, v9
v_perm_b32 v109, v145, v145, v11
v_perm_b32 v110, v145, v145, v13
v_perm_b32 v111, v145, v145, v15
v_mfma_f32_16x16x32_bf16 v[64:67], v[104:107], v[36:39], v[64:67]
s_nop 0
v_mfma_f32_16x16x32_bf16 v[68:71], v[108:111], v[36:39], v[68:71]
v_perm_b32 v96, v146, v146, v8
v_perm_b32 v97, v146, v146, v10
v_perm_b32 v98, v146, v146, v12
v_perm_b32 v99, v146, v146, v14
v_perm_b32 v100, v146, v146, v9
v_perm_b32 v101, v146, v146, v11
v_perm_b32 v102, v146, v146, v13
v_perm_b32 v103, v146, v146, v15
v_mfma_f32_16x16x32_bf16 v[64:67], v[96:99], v[40:43], v[64:67]
s_nop 0
v_mfma_f32_16x16x32_bf16 v[68:71], v[100:103], v[40:43], v[68:71]
v_perm_b32 v104, v147, v147, v8
v_perm_b32 v105, v147, v147, v10
v_perm_b32 v106, v147, v147, v12
v_perm_b32 v107, v147, v147, v14
v_perm_b32 v108, v147, v147, v9
v_perm_b32 v109, v147, v147, v11
v_perm_b32 v110, v147, v147, v13
v_perm_b32 v111, v147, v147, v15
v_mfma_f32_16x16x32_bf16 v[64:67], v[104:107], v[44:47], v[64:67]
s_nop 0
v_mfma_f32_16x16x32_bf16 v[68:71], v[108:111], v[44:47], v[68:71]
v_perm_b32 v96, v148, v148, v8
v_perm_b32 v97, v148, v148, v10
v_perm_b32 v98, v148, v148, v12
v_perm_b32 v99, v148, v148, v14
v_perm_b32 v100, v148, v148, v9
v_perm_b32 v101, v148, v148, v11
v_perm_b32 v102, v148, v148, v13
v_perm_b32 v103, v148, v148, v15
v_mfma_f32_16x16x32_bf16 v[64:67], v[96:99], v[48:51], v[64:67]
s_nop 0
v_mfma_f32_16x16x32_bf16 v[68:71], v[100:103], v[48:51], v[68:71]
v_perm_b32 v104, v149, v149, v8
v_perm_b32 v105, v149, v149, v10
v_perm_b32 v106, v149, v149, v12
v_perm_b32 v107, v149, v149, v14
v_perm_b32 v108, v149, v149, v9
v_perm_b32 v109, v149, v149, v11
v_perm_b32 v110, v149, v149, v13
v_perm_b32 v111, v149, v149, v15
v_mfma_f32_16x16x32_bf16 v[64:67], v[104:107], v[52:55], v[64:67]
s_nop 0
v_mfma_f32_16x16x32_bf16 v[68:71], v[108:111], v[52:55], v[68:71]
v_perm_b32 v96, v150, v150, v8
v_perm_b32 v97, v150, v150, v10
v_perm_b32 v98, v150, v150, v12
v_perm_b32 v99, v150, v150, v14
v_perm_b32 v100, v150, v150, v9
v_perm_b32 v101, v150, v150, v11
v_perm_b32 v102, v150, v150, v13
v_perm_b32 v103, v150, v150, v15
v_mfma_f32_16x16x32_bf16 v[64:67], v[96:99], v[56:59], v[64:67]
s_nop 0
v_mfma_f32_16x16x32_bf16 v[68:71], v[100:103], v[56:59], v[68:71]
v_perm_b32 v104, v151, v151, v8
v_perm_b32 v105, v151, v151, v10
v_perm_b32 v106, v151, v151, v12
v_perm_b32 v107, v151, v151, v14
v_perm_b32 v108, v151, v151, v9
v_perm_b32 v109, v151, v151, v11
v_perm_b32 v110, v151, v151, v13
v_perm_b32 v111, v151, v151, v15
v_mfma_f32_16x16x32_bf16 v[64:67], v[104:107], v[60:63], v[64:67]
s_nop 0
v_mfma_f32_16x16x32_bf16 v[68:71], v[108:111], v[60:63], v[68:71]
v_lshrrev_b32 v22, 1, v17
v_lshlrev_b32 v22, 8, v22
v_and_b32 v23, 1, v17
v_lshlrev_b32 v23, 4, v23
v_add_u32 v22, v22, v23
v_and_b32 v23, 7, v1
v_lshlrev_b32 v23, 5, v23
v_add_u32 v22, v22, v23
s_lshl_b32 s60, s3, 9
v_add_u32 v22, s60, v22
v_cndmask_b32 v64, v64, v68, s[84:85]
v_cndmask_b32 v65, v65, v69, s[84:85]
v_cndmask_b32 v66, v66, v70, s[84:85]
v_cndmask_b32 v67, v67, v71, s[84:85]
v_add_f32_dpp v64, v64, v64 row_ror:8 row_mask:0xf bank_mask:0xf
v_add_f32_dpp v65, v65, v65 row_ror:8 row_mask:0xf bank_mask:0xf
v_add_f32_dpp v66, v66, v66 row_ror:8 row_mask:0xf bank_mask:0xf
v_add_f32_dpp v67, v67, v67 row_ror:8 row_mask:0xf bank_mask:0xf
s_mov_b32 s60, 0x00ff00ff
s_mov_b32 s61, 0x00ff00ff
s_mov_b64 exec, s[60:61]
ds_write_b128 v22, v[64:67] offset:4096
s_mov_b64 exec, 1
s_waitcnt lgkmcnt(0)
v_mov_b32 v23, 1312
v_mov_b32 v24, 1
ds_add_rtn_u32 v25, v23, v24
s_waitcnt lgkmcnt(0)
v_readfirstlane_b32 s60, v25
s_mov_b64 exec, -1
s_cmp_lg_u32 s60, 3
s_cbranch_scc1 L_vw_qdone
v_lshlrev_b32 v22, 3, v1
ds_read_b64 v[96:97], v22 offset:4096
ds_read_b64 v[98:99], v22 offset:4608
ds_read_b64 v[100:101], v22 offset:5120
ds_read_b64 v[102:103], v22 offset:5632
s_lshr_b32 s60, s2, 6
s_lshl_b32 s60, s60, 2
s_and_b32 s61, s2, 3
s_add_u32 s60, s60, s61
s_lshl_b32 s60, s60, 13
s_lshr_b32 s61, s2, 2
s_and_b32 s61, s61, 15
s_lshl_b32 s61, s61, 9
s_add_u32 s60, s60, s61
s_add_u32 s60, s60, 0x10000
v_lshrrev_b32 v23, 5, v1
v_lshlrev_b32 v23, 17, v23
v_and_b32 v24, 31, v1
v_lshlrev_b32 v24, 4, v24
v_add_u32 v23, v23, v24
v_mov_b32 v25, s80
v_mov_b32 v27, s80
s_waitcnt lgkmcnt(0)
v_add_f32 v96, v96, v98
v_add_f32 v97, v97, v99
v_add_f32 v100, v100, v102
v_add_f32 v101, v101, v103
v_add_f32 v24, v96, v100
v_add_f32 v26, v97, v101
buffer_store_dwordx4 v[24:27], v23, s[52:55], s60 offen sc1
L_vw_qdone:
v_and_b32 v22, 1, v1
v_cmp_eq_u32 vcc, 1, v22
v_mov_b32 v22, 0xffff
v_mov_b32 v23, 0xffff0000
v_cndmask_b32 v23, v22, v23, vcc
v_bfe_u32 v22, v1, 1, 2
v_cmp_eq_u32 vcc, 0, v22
s_nop 1
v_cndmask_b32 v8, 0, v23, vcc
v_cmp_eq_u32 vcc, 1, v22
s_nop 1
v_cndmask_b32 v9, 0, v23, vcc
v_cmp_eq_u32 vcc, 2, v22
s_nop 1
v_cndmask_b32 v10, 0, v23, vcc
v_cmp_eq_u32 vcc, 3, v22
s_nop 1
v_cndmask_b32 v11, 0, v23, vcc
s_lshl_b32 s60, s91, 22
s_lshl_b32 s61, s90, 17
s_add_u32 s60, s60, s61
s_add_u32 s40, s20, s60
s_addc_u32 s41, s21, 0
s_mov_b32 s42, 0x20000
s_mov_b32 s43, 0x20000
s_mov_b32 s48, s24
s_mov_b32 s49, s25
s_mov_b32 s50, 0x800000
s_mov_b32 s51, 0x20000
s_lshl_b32 s60, s3, 10
v_lshlrev_b32 v18, 4, v1
v_add_u32 v18, s60, v18
s_lshr_b32 s60, s2, 5
s_lshl_b32 s60, s60, 3
s_add_u32 s97, s60, s91
s_lshr_b32 s60, s97, 3
s_lshl_b32 s60, s60, 9
s_bfe_u32 s61, s97, 0x20001
s_add_u32 s60, s60, s61
s_and_b32 s61, s97, 1
s_lshl_b32 s61, s61, 2
s_add_u32 s60, s60, s61
s_lshr_b32 s61, s3, 1
s_lshl_b32 s61, s61, 6
s_add_u32 s60, s60, s61
s_lshl_b32 s60, s60, 11
s_bfe_u32 s61, s2, 0x20003
s_lshl_b32 s61, s61, 9
s_add_u32 s60, s60, s61
s_and_b32 s61, s3, 1
s_lshl_b32 s61, s61, 8
s_add_u32 s60, s60, s61
v_lshlrev_b32 v19, 18, v17
v_lshlrev_b32 v20, 4, v16
v_add_u32 v19, v19, v20
v_add_u32 v19, s60, v19
s_lshl_b32 s60, s3, 2
s_add_u32 s60, s60, 1280
v_mov_b32 v20, s60
s_mov_b32 s86, 0
L_spin_gate_1:
ds_read_b32 v2, v20
s_add_u32 s86, s86, 1
s_waitcnt lgkmcnt(0)
v_readfirstlane_b32 s60, v2
s_cmp_ge_u32 s60, 1
s_cbranch_scc1 L_done_gate_2
s_cmp_gt_u32 s86, 2000000
s_cbranch_scc1 L_done_gate_2
s_sleep 1
s_branch L_spin_gate_1
L_done_gate_2:
s_mov_b32 s63, 0
buffer_load_dwordx4 v[128:131], v18, s[40:43], s63 offen nt
s_mov_b32 s63, 4096
buffer_load_dwordx4 v[132:135], v18, s[40:43], s63 offen nt
s_mov_b32 s63, 8192
buffer_load_dwordx4 v[136:139], v18, s[40:43], s63 offen nt
s_mov_b32 s63, 12288
buffer_load_dwordx4 v[140:143], v18, s[40:43], s63 offen nt
s_mov_b32 s63, 16384
buffer_load_dwordx4 v[144:147], v18, s[40:43], s63 offen nt
s_mov_b32 s63, 20480
buffer_load_dwordx4 v[148:151], v18, s[40:43], s63 offen nt
s_waitcnt vmcnt(5)
s_mov_b32 s63, 24576
buffer_load_dwordx4 v[152:155], v18, s[40:43], s63 offen nt
s_waitcnt vmcnt(5)
s_mov_b32 s63, 28672
buffer_load_dwordx4 v[156:159], v18, s[40:43], s63 offen nt
s_waitcnt vmcnt(5)
s_mov_b32 s63, 32768
buffer_load_dwordx4 v[160:163], v18, s[40:43], s63 offen nt
s_waitcnt vmcnt(5)
s_mov_b32 s63, 36864
buffer_load_dwordx4 v[164:167], v18, s[40:43], s63 offen nt
s_waitcnt vmcnt(5)
s_mov_b32 s63, 40960
buffer_load_dwordx4 v[168:171], v18, s[40:43], s63 offen nt
s_waitcnt vmcnt(5)
s_mov_b32 s63, 45056
buffer_load_dwordx4 v[172:175], v18, s[40:43], s63 offen nt
s_waitcnt vmcnt(5)
s_mov_b32 s63, 49152
buffer_load_dwordx4 v[176:179], v18, s[40:43], s63 offen nt
s_waitcnt vmcnt(5)
s_mov_b32 s63, 53248
buffer_load_dwordx4 v[180:183], v18, s[40:43], s63 offen nt
s_waitcnt vmcnt(5)
s_mov_b32 s63, 57344
buffer_load_dwordx4 v[184:187], v18, s[40:43], s63 offen nt
s_waitcnt vmcnt(5)
s_mov_b32 s63, 61440
buffer_load_dwordx4 v[188:191], v18, s[40:43], s63 offen nt
s_waitcnt vmcnt(5)
s_mov_b32 s63, 65536
buffer_load_dwordx4 v[192:195], v18, s[40:43], s63 offen nt
s_waitcnt vmcnt(5)
s_mov_b32 s63, 69632
buffer_load_dwordx4 v[196:199], v18, s[40:43], s63 offen nt
s_waitcnt vmcnt(5)
s_mov_b32 s63, 73728
buffer_load_dwordx4 v[200:203], v18, s[40:43], s63 offen nt
s_waitcnt vmcnt(5)
s_mov_b32 s63, 77824
buffer_load_dwordx4 v[204:207], v18, s[40:43], s63 offen nt
s_waitcnt vmcnt(5)
s_mov_b32 s63, 81920
buffer_load_dwordx4 v[208:211], v18, s[40:43], s63 offen nt
s_waitcnt vmcnt(5)
s_mov_b32 s63, 86016
buffer_load_dwordx4 v[212:215], v18, s[40:43], s63 offen nt
s_waitcnt vmcnt(5)
s_mov_b32 s63, 90112
buffer_load_dwordx4 v[216:219], v18, s[40:43], s63 offen nt
s_waitcnt vmcnt(5)
s_mov_b32 s63, 94208
buffer_load_dwordx4 v[220:223], v18, s[40:43], s63 offen nt
s_waitcnt vmcnt(5)
s_mov_b32 s63, 98304
buffer_load_dwordx4 v[224:227], v18, s[40:43], s63 offen nt
s_waitcnt vmcnt(5)
s_mov_b32 s63, 102400
buffer_load_dwordx4 v[228:231], v18, s[40:43], s63 offen nt
s_waitcnt vmcnt(5)
s_mov_b32 s63, 106496
buffer_load_dwordx4 v[232:235], v18, s[40:43], s63 offen nt
s_waitcnt vmcnt(5)
s_mov_b32 s63, 110592
buffer_load_dwordx4 v[236:239], v18, s[40:43], s63 offen nt
s_waitcnt vmcnt(5)
s_mov_b32 s63, 114688
buffer_load_dwordx4 v[240:243], v18, s[40:43], s63 offen nt
s_waitcnt vmcnt(5)
s_mov_b32 s63, 118784
buffer_load_dwordx4 v[244:247], v18, s[40:43], s63 offen nt
s_waitcnt vmcnt(5)
s_mov_b32 s63, 122880
buffer_load_dwordx4 v[248:251], v18, s[40:43], s63 offen nt
s_waitcnt vmcnt(5)
s_mov_b32 s63, 126976
buffer_load_dwordx4 v[252:255], v18, s[40:43], s63 offen nt
s_lshl_b32 s60, s3, 2
s_add_u32 s60, s60, 1328
v_mov_b32 v20, s60
v_mov_b32 v21, 1
ds_write_b32 v20, v21
s_mov_b32 s40, s28
s_mov_b32 s41, s29
s_mov_b32 s42, 0x700000
s_mov_b32 s43, 0x20000
s_mov_b32 s44, s30
s_mov_b32 s45, s31
s_mov_b32 s46, 0x700000
s_mov_b32 s47, 0x20000
s_mul_i32 s60, s96, 229376
s_lshl_b32 s61, s100, 10
s_add_u32 s60, s60, s61
s_lshl_b32 s61, s3, 8
s_add_u32 s60, s60, s61
s_cmp_ge_u32 s2, 224
s_cselect_b32 s61, 0x40000000, 0
s_add_u32 s60, s60, s61
s_mov_b32 s61, 57344
v_mul_lo_u32 v21, v17, s61
v_lshlrev_b32 v20, 4, v16
v_add_u32 v21, v21, v20
v_add_u32 v21, s60, v21
s_lshr_b32 s60, s2, 4
s_lshl_b32 s60, s60, 3
s_add_u32 s101, s60, s91
s_lshl_b32 s60, s101, 16
s_bfe_u32 s61, s2, 0x10003
s_lshl_b32 s61, s61, 10
s_add_u32 s60, s60, s61
s_lshl_b32 s61, s3, 8
s_add_u32 s60, s60, s61
v_lshlrev_b32 v23, 14, v17
v_add_u32 v23, v23, v20
v_add_u32 v23, s60, v23
s_lshl_b32 s60, s3, 2
s_add_u32 s60, s60, 1344
v_mov_b32 v20, s60
s_lshl_b32 s60, s3, 2
s_add_u32 s60, s60, 1296
v_mov_b32 v20, s60
s_mov_b32 s86, 0
L_spin_pflag_3:
ds_read_b32 v2, v20
s_add_u32 s86, s86, 1
s_waitcnt lgkmcnt(0)
v_readfirstlane_b32 s60, v2
s_cmp_ge_u32 s60, 1
s_cbranch_scc1 L_done_pflag_4
s_cmp_gt_u32 s86, 2000000
s_cbranch_scc1 L_done_pflag_4
s_sleep 1
s_branch L_spin_pflag_3
L_done_pflag_4:
v_mov_b32 v64, 0
v_mov_b32 v65, 0
v_mov_b32 v66, 0
v_mov_b32 v67, 0
v_mov_b32 v68, 0
v_mov_b32 v69, 0
v_mov_b32 v70, 0
v_mov_b32 v71, 0
v_mov_b32 v72, 0
v_mov_b32 v73, 0
v_mov_b32 v74, 0
v_mov_b32 v75, 0
v_mov_b32 v76, 0
v_mov_b32 v77, 0
v_mov_b32 v78, 0
v_mov_b32 v79, 0
v_mov_b32 v80, 0
v_mov_b32 v81, 0
v_mov_b32 v82, 0
v_mov_b32 v83, 0
v_mov_b32 v84, 0
v_mov_b32 v85, 0
v_mov_b32 v86, 0
v_mov_b32 v87, 0
v_mov_b32 v88, 0
v_mov_b32 v89, 0
v_mov_b32 v90, 0
v_mov_b32 v91, 0
v_mov_b32 v92, 0
v_mov_b32 v93, 0
v_mov_b32 v94, 0
v_mov_b32 v95, 0
s_lshl_b32 s60, s3, 12
s_add_u32 s60, s60, 4096
v_lshlrev_b32 v20, 4, v1
v_add_u32 v20, s60, v20
ds_read_b128 v[112:115], v20 offset:0
ds_read_b128 v[116:119], v20 offset:1024
s_mov_b32 s64, 0x05040100
s_mov_b32 s65, 0x07060302
s_waitcnt lgkmcnt(1)
v_perm_b32 v96, v132, v128, s64
v_perm_b32 v97, v140, v136, s64
v_perm_b32 v98, v148, v144, s64
v_perm_b32 v99, v156, v152, s64
v_perm_b32 v100, v132, v128, s65
v_perm_b32 v101, v140, v136, s65
v_perm_b32 v102, v148, v144, s65
v_perm_b32 v103, v156, v152, s65
v_mfma_f32_16x16x32_bf16 v[64:67], v[112:115], v[96:99], v[64:67]
s_nop 0
v_mfma_f32_16x16x32_bf16 v[68:71], v[112:115], v[100:103], v[68:71]
v_perm_b32 v104, v133, v129, s64
v_perm_b32 v105, v141, v137, s64
v_perm_b32 v106, v149, v145, s64
v_perm_b32 v107, v157, v153, s64
v_perm_b32 v108, v133, v129, s65
v_perm_b32 v109, v141, v137, s65
v_perm_b32 v110, v149, v145, s65
v_perm_b32 v111, v157, v153, s65
v_mfma_f32_16x16x32_bf16 v[72:75], v[112:115], v[104:107], v[72:75]
s_nop 0
v_mfma_f32_16x16x32_bf16 v[76:79], v[112:115], v[108:111], v[76:79]
v_perm_b32 v96, v134, v130, s64
v_perm_b32 v97, v142, v138, s64
v_perm_b32 v98, v150, v146, s64
v_perm_b32 v99, v158, v154, s64
v_perm_b32 v100, v134, v130, s65
v_perm_b32 v101, v142, v138, s65
v_perm_b32 v102, v150, v146, s65
v_perm_b32 v103, v158, v154, s65
v_mfma_f32_16x16x32_bf16 v[80:83], v[112:115], v[96:99], v[80:83]
s_nop 0
v_mfma_f32_16x16x32_bf16 v[84:87], v[112:115], v[100:103], v[84:87]
v_perm_b32 v104, v135, v131, s64
v_perm_b32 v105, v143, v139, s64
v_perm_b32 v106, v151, v147, s64
v_perm_b32 v107, v159, v155, s64
v_perm_b32 v108, v135, v131, s65
v_perm_b32 v109, v143, v139, s65
v_perm_b32 v110, v151, v147, s65
v_perm_b32 v111, v159, v155, s65
v_mfma_f32_16x16x32_bf16 v[88:91], v[112:115], v[104:107], v[88:91]
s_nop 0
v_mfma_f32_16x16x32_bf16 v[92:95], v[112:115], v[108:111], v[92:95]
ds_read_b128 v[112:115], v20 offset:2048
s_waitcnt lgkmcnt(1)
v_perm_b32 v96, v164, v160, s64
v_perm_b32 v97, v172, v168, s64
v_perm_b32 v98, v180, v176, s64
v_perm_b32 v99, v188, v184, s64
v_perm_b32 v100, v164, v160, s65
v_perm_b32 v101, v172, v168, s65
v_perm_b32 v102, v180, v176, s65
v_perm_b32 v103, v188, v184, s65
v_mfma_f32_16x16x32_bf16 v[64:67], v[116:119], v[96:99], v[64:67]
s_nop 0
v_mfma_f32_16x16x32_bf16 v[68:71], v[116:119], v[100:103], v[68:71]
v_perm_b32 v104, v165, v161, s64
v_perm_b32 v105, v173, v169, s64
v_perm_b32 v106, v181, v177, s64
v_perm_b32 v107, v189, v185, s64
v_perm_b32 v108, v165, v161, s65
v_perm_b32 v109, v173, v169, s65
v_perm_b32 v110, v181, v177, s65
v_perm_b32 v111, v189, v185, s65
v_mfma_f32_16x16x32_bf16 v[72:75], v[116:119], v[104:107], v[72:75]
s_nop 0
v_mfma_f32_16x16x32_bf16 v[76:79], v[116:119], v[108:111], v[76:79]
v_perm_b32 v96, v166, v162, s64
v_perm_b32 v97, v174, v170, s64
v_perm_b32 v98, v182, v178, s64
v_perm_b32 v99, v190, v186, s64
v_perm_b32 v100, v166, v162, s65
v_perm_b32 v101, v174, v170, s65
v_perm_b32 v102, v182, v178, s65
v_perm_b32 v103, v190, v186, s65
v_mfma_f32_16x16x32_bf16 v[80:83], v[116:119], v[96:99], v[80:83]
s_nop 0
v_mfma_f32_16x16x32_bf16 v[84:87], v[116:119], v[100:103], v[84:87]
v_perm_b32 v104, v167, v163, s64
v_perm_b32 v105, v175, v171, s64
v_perm_b32 v106, v183, v179, s64
v_perm_b32 v107, v191, v187, s64
v_perm_b32 v108, v167, v163, s65
v_perm_b32 v109, v175, v171, s65
v_perm_b32 v110, v183, v179, s65
v_perm_b32 v111, v191, v187, s65
v_mfma_f32_16x16x32_bf16 v[88:91], v[116:119], v[104:107], v[88:91]
s_nop 0
v_mfma_f32_16x16x32_bf16 v[92:95], v[116:119], v[108:111], v[92:95]
ds_read_b128 v[116:119], v20 offset:3072
s_waitcnt lgkmcnt(1)
v_perm_b32 v96, v196, v192, s64
v_perm_b32 v97, v204, v200, s64
v_perm_b32 v98, v212, v208, s64
v_perm_b32 v99, v220, v216, s64
v_perm_b32 v100, v196, v192, s65
v_perm_b32 v101, v204, v200, s65
v_perm_b32 v102, v212, v208, s65
v_perm_b32 v103, v220, v216, s65
v_mfma_f32_16x16x32_bf16 v[64:67], v[112:115], v[96:99], v[64:67]
s_nop 0
v_mfma_f32_16x16x32_bf16 v[68:71], v[112:115], v[100:103], v[68:71]
v_perm_b32 v104, v197, v193, s64
v_perm_b32 v105, v205, v201, s64
v_perm_b32 v106, v213, v209, s64
v_perm_b32 v107, v221, v217, s64
v_perm_b32 v108, v197, v193, s65
v_perm_b32 v109, v205, v201, s65
v_perm_b32 v110, v213, v209, s65
v_perm_b32 v111, v221, v217, s65
v_mfma_f32_16x16x32_bf16 v[72:75], v[112:115], v[104:107], v[72:75]
s_nop 0
v_mfma_f32_16x16x32_bf16 v[76:79], v[112:115], v[108:111], v[76:79]
v_perm_b32 v96, v198, v194, s64
v_perm_b32 v97, v206, v202, s64
v_perm_b32 v98, v214, v210, s64
v_perm_b32 v99, v222, v218, s64
v_perm_b32 v100, v198, v194, s65
v_perm_b32 v101, v206, v202, s65
v_perm_b32 v102, v214, v210, s65
v_perm_b32 v103, v222, v218, s65
v_mfma_f32_16x16x32_bf16 v[80:83], v[112:115], v[96:99], v[80:83]
s_nop 0
v_mfma_f32_16x16x32_bf16 v[84:87], v[112:115], v[100:103], v[84:87]
v_perm_b32 v104, v199, v195, s64
v_perm_b32 v105, v207, v203, s64
v_perm_b32 v106, v215, v211, s64
v_perm_b32 v107, v223, v219, s64
v_perm_b32 v108, v199, v195, s65
v_perm_b32 v109, v207, v203, s65
v_perm_b32 v110, v215, v211, s65
v_perm_b32 v111, v223, v219, s65
v_mfma_f32_16x16x32_bf16 v[88:91], v[112:115], v[104:107], v[88:91]
s_nop 0
v_mfma_f32_16x16x32_bf16 v[92:95], v[112:115], v[108:111], v[92:95]
s_waitcnt vmcnt(0)
s_waitcnt lgkmcnt(0)
v_perm_b32 v96, v228, v224, s64
v_perm_b32 v97, v236, v232, s64
v_perm_b32 v98, v244, v240, s64
v_perm_b32 v99, v252, v248, s64
v_perm_b32 v100, v228, v224, s65
v_perm_b32 v101, v236, v232, s65
v_perm_b32 v102, v244, v240, s65
v_perm_b32 v103, v252, v248, s65
v_mfma_f32_16x16x32_bf16 v[64:67], v[116:119], v[96:99], v[64:67]
s_nop 0
v_mfma_f32_16x16x32_bf16 v[68:71], v[116:119], v[100:103], v[68:71]
v_perm_b32 v104, v229, v225, s64
v_perm_b32 v105, v237, v233, s64
v_perm_b32 v106, v245, v241, s64
v_perm_b32 v107, v253, v249, s64
v_perm_b32 v108, v229, v225, s65
v_perm_b32 v109, v237, v233, s65
v_perm_b32 v110, v245, v241, s65
v_perm_b32 v111, v253, v249, s65
v_mfma_f32_16x16x32_bf16 v[72:75], v[116:119], v[104:107], v[72:75]
s_nop 0
v_mfma_f32_16x16x32_bf16 v[76:79], v[116:119], v[108:111], v[76:79]
v_perm_b32 v96, v230, v226, s64
v_perm_b32 v97, v238, v234, s64
v_perm_b32 v98, v246, v242, s64
v_perm_b32 v99, v254, v250, s64
v_perm_b32 v100, v230, v226, s65
v_perm_b32 v101, v238, v234, s65
v_perm_b32 v102, v246, v242, s65
v_perm_b32 v103, v254, v250, s65
v_mfma_f32_16x16x32_bf16 v[80:83], v[116:119], v[96:99], v[80:83]
s_nop 0
v_mfma_f32_16x16x32_bf16 v[84:87], v[116:119], v[100:103], v[84:87]
v_perm_b32 v104, v231, v227, s64
v_perm_b32 v105, v239, v235, s64
v_perm_b32 v106, v247, v243, s64
v_perm_b32 v107, v255, v251, s64
v_perm_b32 v108, v231, v227, s65
v_perm_b32 v109, v239, v235, s65
v_perm_b32 v110, v247, v243, s65
v_perm_b32 v111, v255, v251, s65
v_mfma_f32_16x16x32_bf16 v[88:91], v[116:119], v[104:107], v[88:91]
s_nop 0
v_mfma_f32_16x16x32_bf16 v[92:95], v[116:119], v[108:111], v[92:95]
v_permlane32_swap_b32 v64, v80
v_permlane32_swap_b32 v65, v81
v_permlane32_swap_b32 v66, v82
v_permlane32_swap_b32 v67, v83
v_permlane32_swap_b32 v68, v84
v_permlane32_swap_b32 v69, v85
v_permlane32_swap_b32 v70, v86
v_permlane32_swap_b32 v71, v87
v_permlane32_swap_b32 v72, v88
v_permlane32_swap_b32 v73, v89
v_permlane32_swap_b32 v74, v90
v_permlane32_swap_b32 v75, v91
v_permlane32_swap_b32 v76, v92
v_permlane32_swap_b32 v77, v93
v_permlane32_swap_b32 v78, v94
v_permlane32_swap_b32 v79, v95
ds_write_b128 v20, v[64:67] offset:0
ds_write_b128 v20, v[68:71] offset:1024
ds_write_b128 v20, v[72:75] offset:2048
ds_write_b128 v20, v[76:79] offset:3072
s_mov_b32 s63, 0
buffer_load_dwordx4 v[32:35], v19, s[48:51], s63 offen nt
s_mov_b32 s63, 16384
buffer_load_dwordx4 v[36:39], v19, s[48:51], s63 offen nt
s_mov_b32 s63, 32768
buffer_load_dwordx4 v[40:43], v19, s[48:51], s63 offen nt
s_waitcnt lgkmcnt(0)
s_barrier
s_barrier
s_mov_b32 s63, 49152
buffer_load_dwordx4 v[44:47], v19, s[48:51], s63 offen nt
s_mov_b32 s63, 65536
buffer_load_dwordx4 v[48:51], v19, s[48:51], s63 offen nt
s_mov_b32 s63, 81920
buffer_load_dwordx4 v[52:55], v19, s[48:51], s63 offen nt
s_mov_b32 s63, 98304
buffer_load_dwordx4 v[56:59], v19, s[48:51], s63 offen nt
s_mov_b32 s63, 114688
buffer_load_dwordx4 v[60:63], v19, s[48:51], s63 offen nt
s_lshl_b32 s60, s97, 2
s_bfe_u32 s61, s2, 0x20003
s_add_u32 s60, s60, s61
s_mul_i32 s60, s60, 2304
s_and_b32 s61, s3, 1
s_lshl_b32 s61, s61, 10
s_add_u32 s60, s60, s61
s_add_u32 s60, s60, 0x170000
v_lshrrev_b32 v24, 2, v16
v_lshlrev_b32 v24, 8, v24
v_lshrrev_b32 v25, 1, v17
v_lshlrev_b32 v25, 7, v25
v_add_u32 v24, v24, v25
v_and_b32 v25, 3, v16
v_lshlrev_b32 v25, 5, v25
v_add_u32 v24, v24, v25
v_and_b32 v25, 1, v17
v_lshlrev_b32 v25, 4, v25
v_add_u32 v24, v24, v25
v_add_u32 v24, s60, v24
v_lshrrev_b32 v25, 3, v16
v_lshlrev_b32 v25, 8, v25
v_lshlrev_b32 v26, 6, v17
v_add_u32 v25, v25, v26
s_lshr_b32 s60, s3, 1
s_lshl_b32 s60, s60, 5
v_add_u32 v25, s60, v25
v_lshrrev_b32 v125, 3, v16
v_lshlrev_b32 v125, 7, v125
v_lshlrev_b32 v124, 5, v17
v_add_u32 v125, v125, v124
s_and_b32 s60, s3, 1
s_lshl_b32 s60, s60, 10
s_add_u32 s60, s60, 22528
v_lshlrev_b32 v26, 4, v1
v_add_u32 v26, s60, v26
s_waitcnt vmcnt(0)
s_barrier
s_setprio 3
ds_read_b128 v[96:99], v25 offset:24576
ds_read_b128 v[100:103], v25 offset:24592
s_mov_b32 s63, 0
buffer_load_dwordx4 v[128:131], v21, s[40:43], s63 offen nt
s_mov_b32 s63, 7168
buffer_load_dwordx4 v[132:135], v21, s[40:43], s63 offen nt
s_mov_b32 s63, 14336
buffer_load_dwordx4 v[136:139], v21, s[40:43], s63 offen nt
s_mov_b32 s63, 21504
buffer_load_dwordx4 v[140:143], v21, s[40:43], s63 offen nt
s_waitcnt lgkmcnt(0)
v_and_b32 v112, v96, v8
v_and_b32 v113, v96, v9
v_and_b32 v114, v96, v10
v_and_b32 v115, v96, v11
v_and_b32 v116, v97, v8
v_and_b32 v117, v97, v9
v_and_b32 v118, v97, v10
v_and_b32 v119, v97, v11
v_mfma_f32_16x16x32_bf16 v[64:67], v[112:115], v[32:35], 0
v_and_b32 v112, v98, v8
v_and_b32 v113, v98, v9
v_and_b32 v114, v98, v10
v_and_b32 v115, v98, v11
v_mfma_f32_16x16x32_bf16 v[68:71], v[116:119], v[36:39], 0
v_and_b32 v116, v99, v8
v_and_b32 v117, v99, v9
v_and_b32 v118, v99, v10
v_and_b32 v119, v99, v11
v_mfma_f32_16x16x32_bf16 v[64:67], v[112:115], v[40:43], v[64:67]
v_and_b32 v112, v100, v8
v_and_b32 v113, v100, v9
v_and_b32 v114, v100, v10
v_and_b32 v115, v100, v11
v_mfma_f32_16x16x32_bf16 v[68:71], v[116:119], v[44:47], v[68:71]
v_and_b32 v116, v101, v8
v_and_b32 v117, v101, v9
v_and_b32 v118, v101, v10
v_and_b32 v119, v101, v11
v_mfma_f32_16x16x32_bf16 v[64:67], v[112:115], v[48:51], v[64:67]
v_and_b32 v112, v102, v8
v_and_b32 v113, v102, v9
v_and_b32 v114, v102, v10
v_and_b32 v115, v102, v11
v_mfma_f32_16x16x32_bf16 v[68:71], v[116:119], v[52:55], v[68:71]
v_and_b32 v116, v103, v8
v_and_b32 v117, v103, v9
v_and_b32 v118, v103, v10
v_and_b32 v119, v103, v11
v_mfma_f32_16x16x32_bf16 v[64:67], v[112:115], v[56:59], v[64:67]
s_nop 0
v_mfma_f32_16x16x32_bf16 v[68:71], v[116:119], v[60:63], v[68:71]
s_nop 7
v_add_f32 v64, v64, v68
v_add_f32 v65, v65, v69
v_add_f32 v66, v66, v70
v_add_f32 v67, v67, v71
s_cmp_lt_u32 s3, 2
s_cbranch_scc1 L_rh0_5
ds_write_b128 v26, v[64:67]
s_waitcnt lgkmcnt(0)
s_barrier
s_branch L_rhd_6
L_rh0_5:
s_barrier
ds_read_b128 v[96:99], v26
s_waitcnt lgkmcnt(0)
v_add_f32 v64, v64, v96
v_add_f32 v65, v65, v97
v_add_f32 v66, v66, v98
v_add_f32 v67, v67, v99
v_bfi_b32 v64, s87, v4, v64
v_bfi_b32 v65, s87, v5, v65
v_bfi_b32 v66, s87, v6, v66
v_bfi_b32 v67, s87, v7, v67
buffer_store_dwordx4 v[64:67], v24, s[52:55], 0 offen sc1
L_rhd_6:
s_barrier
s_mov_b32 s63, 28672
buffer_load_dwordx4 v[144:147], v21, s[40:43], s63 offen nt
s_mov_b32 s63, 35840
buffer_load_dwordx4 v[148:151], v21, s[40:43], s63 offen nt
s_mov_b32 s63, 43008
buffer_load_dwordx4 v[152:155], v21, s[40:43], s63 offen nt
s_mov_b32 s63, 50176
buffer_load_dwordx4 v[156:159], v21, s[40:43], s63 offen nt
s_barrier
v_mov_b32 v104, 0x3f803f80
v_and_b32 v112, v104, v8
v_and_b32 v113, v104, v9
v_and_b32 v114, v104, v10
v_and_b32 v115, v104, v11
s_mul_i32 s60, s96, 7
s_add_u32 s60, s60, s100
s_mul_i32 s60, s60, 7424
s_mul_i32 s61, s3, 1536
s_add_u32 s60, s60, s61
s_add_u32 s60, s60, 0x210000
v_lshrrev_b32 v26, 2, v16
v_mul_u32_u24 v26, 384, v26
v_and_b32 v27, 3, v16
v_lshlrev_b32 v27, 5, v27
v_add_u32 v26, v26, v27
v_and_b32 v27, 1, v17
v_lshlrev_b32 v27, 4, v27
v_add_u32 v26, v26, v27
v_add_u32 v26, s60, v26
v_lshrrev_b32 v27, 1, v17
v_lshlrev_b32 v27, 7, v27
v_add_u32 v28, v26, v27
v_add_u32 v29, 256, v26
s_waitcnt vmcnt(4)
v_mfma_f32_16x16x32_bf16 v[200:203], v[112:115], v[128:131], 0
v_mfma_f32_16x16x32_bf16 v[200:203], v[112:115], v[132:135], v[200:203]
v_mfma_f32_16x16x32_bf16 v[200:203], v[112:115], v[136:139], v[200:203]
v_mfma_f32_16x16x32_bf16 v[200:203], v[112:115], v[140:143], v[200:203]
s_waitcnt vmcnt(0)
v_mfma_f32_16x16x32_bf16 v[200:203], v[112:115], v[144:147], v[200:203]
v_mfma_f32_16x16x32_bf16 v[200:203], v[112:115], v[148:151], v[200:203]
v_mfma_f32_16x16x32_bf16 v[200:203], v[112:115], v[152:155], v[200:203]
v_mfma_f32_16x16x32_bf16 v[200:203], v[112:115], v[156:159], v[200:203]
s_cmp_ge_u32 s2, 224
s_cbranch_scc1 L_noc_7
s_nop 5
v_bfi_b32 v200, s87, v4, v200
v_bfi_b32 v201, s87, v5, v201
v_bfi_b32 v202, s87, v6, v202
v_bfi_b32 v203, s87, v7, v203
s_mov_b32 exec_hi, 0
buffer_store_dwordx4 v[200:203], v29, s[52:55], 0 offen sc1
s_mov_b64 exec, -1
L_noc_7:
s_barrier
s_cmp_ge_u32 s2, 224
s_cbranch_scc1 L_fin
ds_read_b128 v[96:99], v125 offset:25088
ds_read_b128 v[100:103], v125 offset:25104
s_mov_b32 s63, 0
buffer_load_dwordx4 v[160:163], v23, s[44:47], s63 offen nt
s_mov_b32 s63, 2048
buffer_load_dwordx4 v[164:167], v23, s[44:47], s63 offen nt
s_mov_b32 s63, 4096
buffer_load_dwordx4 v[168:171], v23, s[44:47], s63 offen nt
s_mov_b32 s63, 6144
buffer_load_dwordx4 v[172:175], v23, s[44:47], s63 offen nt
s_waitcnt lgkmcnt(0)
v_and_b32 v112, v96, v8
v_and_b32 v113, v96, v9
v_and_b32 v114, v96, v10
v_and_b32 v115, v96, v11
v_and_b32 v116, v97, v8
v_and_b32 v117, v97, v9
v_and_b32 v118, v97, v10
v_and_b32 v119, v97, v11
v_mfma_f32_16x16x32_bf16 v[192:195], v[112:115], v[128:131], 0
v_and_b32 v112, v98, v8
v_and_b32 v113, v98, v9
v_and_b32 v114, v98, v10
v_and_b32 v115, v98, v11
v_mfma_f32_16x16x32_bf16 v[196:199], v[116:119], v[132:135], 0
v_and_b32 v116, v99, v8
v_and_b32 v117, v99, v9
v_and_b32 v118, v99, v10
v_and_b32 v119, v99, v11
v_mfma_f32_16x16x32_bf16 v[192:195], v[112:115], v[136:139], v[192:195]
v_and_b32 v112, v100, v8
v_and_b32 v113, v100, v9
v_and_b32 v114, v100, v10
v_and_b32 v115, v100, v11
v_mfma_f32_16x16x32_bf16 v[196:199], v[116:119], v[140:143], v[196:199]
v_and_b32 v116, v101, v8
v_and_b32 v117, v101, v9
v_and_b32 v118, v101, v10
v_and_b32 v119, v101, v11
v_mfma_f32_16x16x32_bf16 v[192:195], v[112:115], v[144:147], v[192:195]
v_and_b32 v112, v102, v8
v_and_b32 v113, v102, v9
v_and_b32 v114, v102, v10
v_and_b32 v115, v102, v11
v_mfma_f32_16x16x32_bf16 v[196:199], v[116:119], v[148:151], v[196:199]
v_and_b32 v116, v103, v8
v_and_b32 v117, v103, v9
v_and_b32 v118, v103, v10
v_and_b32 v119, v103, v11
v_mfma_f32_16x16x32_bf16 v[192:195], v[112:115], v[152:155], v[192:195]
s_nop 0
v_mfma_f32_16x16x32_bf16 v[196:199], v[116:119], v[156:159], v[196:199]
s_nop 7
v_add_f32 v192, v192, v196
v_add_f32 v193, v193, v197
v_add_f32 v194, v194, v198
v_add_f32 v195, v195, v199
v_bfi_b32 v192, s87, v4, v192
v_bfi_b32 v193, s87, v5, v193
v_bfi_b32 v194, s87, v6, v194
v_bfi_b32 v195, s87, v7, v195
buffer_store_dwordx4 v[192:195], v28, s[52:55], 0 offen sc1
s_barrier
s_mov_b32 s63, 8192
buffer_load_dwordx4 v[176:179], v23, s[44:47], s63 offen nt
s_mov_b32 s63, 10240
buffer_load_dwordx4 v[180:183], v23, s[44:47], s63 offen nt
s_mov_b32 s63, 12288
buffer_load_dwordx4 v[184:187], v23, s[44:47], s63 offen nt
s_mov_b32 s63, 14336
buffer_load_dwordx4 v[188:191], v23, s[44:47], s63 offen nt
s_barrier
s_lshl_b32 s60, s101, 1
s_bfe_u32 s61, s2, 0x10003
s_add_u32 s60, s60, s61
s_mul_i32 s60, s60, 4352
s_lshl_b32 s61, s3, 10
s_add_u32 s60, s60, s61
s_add_u32 s60, s60, 0x3b0000
v_lshrrev_b32 v24, 1, v16
v_lshlrev_b32 v24, 7, v24
v_lshrrev_b32 v25, 1, v17
v_lshlrev_b32 v25, 6, v25
v_add_u32 v24, v24, v25
v_and_b32 v25, 1, v16
v_lshlrev_b32 v25, 5, v25
v_add_u32 v24, v24, v25
v_and_b32 v25, 1, v17
v_lshlrev_b32 v25, 4, v25
v_add_u32 v24, v24, v25
v_add_u32 v24, s60, v24
s_waitcnt vmcnt(0)
s_barrier
ds_read_b128 v[96:99], v125 offset:25344
ds_read_b128 v[100:103], v125 offset:25360
s_waitcnt lgkmcnt(0)
v_and_b32 v112, v96, v8
v_and_b32 v113, v96, v9
v_and_b32 v114, v96, v10
v_and_b32 v115, v96, v11
v_and_b32 v116, v97, v8
v_and_b32 v117, v97, v9
v_and_b32 v118, v97, v10
v_and_b32 v119, v97, v11
v_mfma_f32_16x16x32_bf16 v[192:195], v[112:115], v[160:163], 0
v_and_b32 v112, v98, v8
v_and_b32 v113, v98, v9
v_and_b32 v114, v98, v10
v_and_b32 v115, v98, v11
v_mfma_f32_16x16x32_bf16 v[196:199], v[116:119], v[164:167], 0
v_and_b32 v116, v99, v8
v_and_b32 v117, v99, v9
v_and_b32 v118, v99, v10
v_and_b32 v119, v99, v11
v_mfma_f32_16x16x32_bf16 v[192:195], v[112:115], v[168:171], v[192:195]
v_and_b32 v112, v100, v8
v_and_b32 v113, v100, v9
v_and_b32 v114, v100, v10
v_and_b32 v115, v100, v11
v_mfma_f32_16x16x32_bf16 v[196:199], v[116:119], v[172:175], v[196:199]
v_and_b32 v116, v101, v8
v_and_b32 v117, v101, v9
v_and_b32 v118, v101, v10
v_and_b32 v119, v101, v11
v_mfma_f32_16x16x32_bf16 v[192:195], v[112:115], v[176:179], v[192:195]
v_and_b32 v112, v102, v8
v_and_b32 v113, v102, v9
v_and_b32 v114, v102, v10
v_and_b32 v115, v102, v11
v_mfma_f32_16x16x32_bf16 v[196:199], v[116:119], v[180:183], v[196:199]
v_and_b32 v116, v103, v8
v_and_b32 v117, v103, v9
v_and_b32 v118, v103, v10
v_and_b32 v119, v103, v11
v_mfma_f32_16x16x32_bf16 v[192:195], v[112:115], v[184:187], v[192:195]
s_nop 0
v_mfma_f32_16x16x32_bf16 v[196:199], v[116:119], v[188:191], v[196:199]
s_nop 7
v_add_f32 v192, v192, v196
v_add_f32 v193, v193, v197
v_add_f32 v194, v194, v198
v_add_f32 v195, v195, v199
v_bfi_b32 v192, s87, v4, v192
v_bfi_b32 v193, s87, v5, v193
v_bfi_b32 v194, s87, v6, v194
v_bfi_b32 v195, s87, v7, v195
buffer_store_dwordx4 v[192:195], v24, s[52:55], 0 offen sc1
s_barrier
s_branch L_final
L_kw:
s_setprio 2
s_sub_u32 s99, s3, 4
s_lshl_b32 s66, s91, 22
s_lshl_b32 s61, s90, 17
s_add_u32 s66, s66, s61
v_and_b32 v16, 15, v1
v_lshrrev_b32 v17, 4, v1
v_and_b32 v18, 3, v16
v_lshlrev_b32 v18, 4, v18
v_bfe_u32 v19, v16, 2, 1
v_add_u32 v18, v18, v19
s_lshl_b32 s60, s99, 2
v_add_u32 v18, s60, v18
v_lshlrev_b32 v18, 8, v18
v_lshrrev_b32 v19, 3, v16
v_lshlrev_b32 v19, 6, v19
v_add_u32 v18, v18, v19
v_lshlrev_b32 v19, 4, v17
v_add_u32 v18, v18, v19
s_waitcnt lgkmcnt(0)
s_mov_b32 s52, s36
s_mov_b32 s53, s37
s_mov_b32 s54, 0x4a0000
s_mov_b32 s55, 0x20000
s_add_u32 s40, s18, s66
s_addc_u32 s41, s19, 0
s_mov_b32 s42, 0x20000
s_mov_b32 s43, 0x20000
v_mov_b32 v9, 0
buffer_load_dword v2, v9, s[52:55], 0 offen sc1
s_barrier
s_mov_b32 s63, 0
buffer_load_dwordx4 v[128:131], v18, s[40:43], s63 offen offset:0 nt
s_mov_b32 s63, 0
buffer_load_dwordx4 v[132:135], v18, s[40:43], s63 offen offset:128 nt
s_mov_b32 s63, 16384
buffer_load_dwordx4 v[136:139], v18, s[40:43], s63 offen offset:0 nt
s_mov_b32 s63, 16384
buffer_load_dwordx4 v[140:143], v18, s[40:43], s63 offen offset:128 nt
s_mov_b32 s63, 0
buffer_load_dwordx4 v[144:147], v18, s[40:43], s63 offen offset:512 nt
s_mov_b32 s63, 0
buffer_load_dwordx4 v[148:151], v18, s[40:43], s63 offen offset:640 nt
s_waitcnt vmcnt(7)
s_mov_b32 s63, 16384
buffer_load_dwordx4 v[152:155], v18, s[40:43], s63 offen offset:512 nt
s_waitcnt vmcnt(7)
s_mov_b32 s63, 16384
buffer_load_dwordx4 v[156:159], v18, s[40:43], s63 offen offset:640 nt
s_waitcnt vmcnt(7)
s_mov_b32 s63, 32768
buffer_load_dwordx4 v[160:163], v18, s[40:43], s63 offen offset:0 nt
s_waitcnt vmcnt(7)
s_mov_b32 s63, 32768
buffer_load_dwordx4 v[164:167], v18, s[40:43], s63 offen offset:128 nt
s_waitcnt vmcnt(7)
s_mov_b32 s63, 49152
buffer_load_dwordx4 v[168:171], v18, s[40:43], s63 offen offset:0 nt
s_waitcnt vmcnt(7)
s_mov_b32 s63, 49152
buffer_load_dwordx4 v[172:175], v18, s[40:43], s63 offen offset:128 nt
s_waitcnt vmcnt(7)
s_mov_b32 s63, 32768
buffer_load_dwordx4 v[176:179], v18, s[40:43], s63 offen offset:512 nt
s_waitcnt vmcnt(7)
s_mov_b32 s63, 32768
buffer_load_dwordx4 v[180:183], v18, s[40:43], s63 offen offset:640 nt
s_waitcnt vmcnt(7)
s_mov_b32 s63, 49152
buffer_load_dwordx4 v[184:187], v18, s[40:43], s63 offen offset:512 nt
s_waitcnt vmcnt(7)
s_mov_b32 s63, 49152
buffer_load_dwordx4 v[188:191], v18, s[40:43], s63 offen offset:640 nt
s_waitcnt vmcnt(7)
s_mov_b32 s63, 65536
buffer_load_dwordx4 v[192:195], v18, s[40:43], s63 offen offset:0 nt
s_waitcnt vmcnt(7)
s_mov_b32 s63, 65536
buffer_load_dwordx4 v[196:199], v18, s[40:43], s63 offen offset:128 nt
s_waitcnt vmcnt(7)
s_mov_b32 s63, 81920
buffer_load_dwordx4 v[200:203], v18, s[40:43], s63 offen offset:0 nt
s_waitcnt vmcnt(7)
s_mov_b32 s63, 81920
buffer_load_dwordx4 v[204:207], v18, s[40:43], s63 offen offset:128 nt
s_waitcnt vmcnt(7)
s_mov_b32 s63, 65536
buffer_load_dwordx4 v[208:211], v18, s[40:43], s63 offen offset:512 nt
s_waitcnt vmcnt(7)
s_mov_b32 s63, 65536
buffer_load_dwordx4 v[212:215], v18, s[40:43], s63 offen offset:640 nt
s_waitcnt vmcnt(7)
s_mov_b32 s63, 81920
buffer_load_dwordx4 v[216:219], v18, s[40:43], s63 offen offset:512 nt
s_waitcnt vmcnt(7)
s_mov_b32 s63, 81920
buffer_load_dwordx4 v[220:223], v18, s[40:43], s63 offen offset:640 nt
v_readfirstlane_b32 s98, v2
s_add_u32 s80, s98, 1
s_and_b32 s60, s80, 1023
v_mov_b32 v4, s60
s_mul_i32 s60, s80, 3
s_lshr_b32 s61, s80, 10
s_add_u32 s60, s60, s61
s_and_b32 s60, s60, 1023
v_mov_b32 v5, s60
s_mul_i32 s60, s80, 5
s_lshr_b32 s61, s80, 20
s_add_u32 s60, s60, s61
s_and_b32 s60, s60, 1023
v_mov_b32 v6, s60
s_mul_i32 s60, s80, 7
s_lshr_b32 s61, s80, 15
s_mul_i32 s61, s61, 3
s_add_u32 s60, s60, s61
s_and_b32 s60, s60, 1023
v_mov_b32 v7, s60
s_mov_b32 s87, 1023
s_lshl_b32 s60, s91, 15
s_lshl_b32 s61, s99, 11
s_add_u32 s60, s60, s61
s_add_u32 s60, s60, 0x10000
v_lshlrev_b32 v19, 4, v1
v_add_u32 v19, s60, v19
s_lshl_b32 s60, s99, 2
s_add_u32 s60, s60, 1280
v_mov_b32 v21, s60
v_mov_b32 v22, 1
s_waitcnt vmcnt(7)
s_mov_b32 s63, 98304
buffer_load_dwordx4 v[224:227], v18, s[40:43], s63 offen offset:0 nt
s_waitcnt vmcnt(7)
s_mov_b32 s63, 98304
buffer_load_dwordx4 v[228:231], v18, s[40:43], s63 offen offset:128 nt
s_waitcnt vmcnt(7)
s_mov_b32 s63, 114688
buffer_load_dwordx4 v[232:235], v18, s[40:43], s63 offen offset:0 nt
s_waitcnt vmcnt(7)
s_mov_b32 s63, 114688
buffer_load_dwordx4 v[236:239], v18, s[40:43], s63 offen offset:128 nt
s_waitcnt vmcnt(7)
s_mov_b32 s63, 98304
buffer_load_dwordx4 v[240:243], v18, s[40:43], s63 offen offset:512 nt
s_waitcnt vmcnt(7)
s_mov_b32 s63, 98304
buffer_load_dwordx4 v[244:247], v18, s[40:43], s63 offen offset:640 nt
s_waitcnt vmcnt(7)
s_mov_b32 s63, 114688
buffer_load_dwordx4 v[248:251], v18, s[40:43], s63 offen offset:512 nt
s_waitcnt vmcnt(7)
s_mov_b32 s63, 114688
buffer_load_dwordx4 v[252:255], v18, s[40:43], s63 offen offset:640 nt
s_mov_b32 s86, 0
s_mov_b32 s63, 0
buffer_load_dwordx4 v[64:67], v19, s[52:55], s63 offen offset:0 sc1
buffer_load_dwordx4 v[68:71], v19, s[52:55], s63 offen offset:1024 sc1
s_mov_b32 s63, 8192
buffer_load_dwordx4 v[72:75], v19, s[52:55], s63 offen offset:0 sc1
buffer_load_dwordx4 v[76:79], v19, s[52:55], s63 offen offset:1024 sc1
s_mov_b32 s63, 16384
buffer_load_dwordx4 v[80:83], v19, s[52:55], s63 offen offset:0 sc1
buffer_load_dwordx4 v[84:87], v19, s[52:55], s63 offen offset:1024 sc1
s_mov_b32 s63, 24576
buffer_load_dwordx4 v[88:91], v19, s[52:55], s63 offen offset:0 sc1
buffer_load_dwordx4 v[92:95], v19, s[52:55], s63 offen offset:1024 sc1
ds_write_b32 v21, v22
s_waitcnt vmcnt(0)
v_xor_b32 v20, s80, v65
v_mov_b32 v21, s80
v_bitop3_b32 v20, v20, v67, v21 bitop3:0xf6
v_bitop3_b32 v20, v20, v69, v21 bitop3:0xf6
v_bitop3_b32 v20, v20, v71, v21 bitop3:0xf6
v_bitop3_b32 v20, v20, v73, v21 bitop3:0xf6
v_bitop3_b32 v20, v20, v75, v21 bitop3:0xf6
v_bitop3_b32 v20, v20, v77, v21 bitop3:0xf6
v_bitop3_b32 v20, v20, v79, v21 bitop3:0xf6
v_bitop3_b32 v20, v20, v81, v21 bitop3:0xf6
v_bitop3_b32 v20, v20, v83, v21 bitop3:0xf6
v_bitop3_b32 v20, v20, v85, v21 bitop3:0xf6
v_bitop3_b32 v20, v20, v87, v21 bitop3:0xf6
v_bitop3_b32 v20, v20, v89, v21 bitop3:0xf6
v_bitop3_b32 v20, v20, v91, v21 bitop3:0xf6
v_bitop3_b32 v20, v20, v93, v21 bitop3:0xf6
v_bitop3_b32 v20, v20, v95, v21 bitop3:0xf6
v_cmp_ne_u32 vcc, 0, v20
s_cbranch_vccz L_pdone_q_9
L_poll_q_8:
s_mov_b32 s63, 0
buffer_load_dwordx4 v[64:67], v19, s[52:55], s63 offen offset:0 sc1
buffer_load_dwordx4 v[68:71], v19, s[52:55], s63 offen offset:1024 sc1
s_mov_b32 s63, 8192
buffer_load_dwordx4 v[72:75], v19, s[52:55], s63 offen offset:0 sc1
buffer_load_dwordx4 v[76:79], v19, s[52:55], s63 offen offset:1024 sc1
s_mov_b32 s63, 16384
buffer_load_dwordx4 v[80:83], v19, s[52:55], s63 offen offset:0 sc1
buffer_load_dwordx4 v[84:87], v19, s[52:55], s63 offen offset:1024 sc1
s_mov_b32 s63, 24576
buffer_load_dwordx4 v[88:91], v19, s[52:55], s63 offen offset:0 sc1
buffer_load_dwordx4 v[92:95], v19, s[52:55], s63 offen offset:1024 sc1
s_add_u32 s86, s86, 1
s_waitcnt vmcnt(0)
v_xor_b32 v20, s80, v65
v_mov_b32 v21, s80
v_bitop3_b32 v20, v20, v67, v21 bitop3:0xf6
v_bitop3_b32 v20, v20, v69, v21 bitop3:0xf6
v_bitop3_b32 v20, v20, v71, v21 bitop3:0xf6
v_bitop3_b32 v20, v20, v73, v21 bitop3:0xf6
v_bitop3_b32 v20, v20, v75, v21 bitop3:0xf6
v_bitop3_b32 v20, v20, v77, v21 bitop3:0xf6
v_bitop3_b32 v20, v20, v79, v21 bitop3:0xf6
v_bitop3_b32 v20, v20, v81, v21 bitop3:0xf6
v_bitop3_b32 v20, v20, v83, v21 bitop3:0xf6
v_bitop3_b32 v20, v20, v85, v21 bitop3:0xf6
v_bitop3_b32 v20, v20, v87, v21 bitop3:0xf6
v_bitop3_b32 v20, v20, v89, v21 bitop3:0xf6
v_bitop3_b32 v20, v20, v91, v21 bitop3:0xf6
v_bitop3_b32 v20, v20, v93, v21 bitop3:0xf6
v_bitop3_b32 v20, v20, v95, v21 bitop3:0xf6
v_cmp_ne_u32 vcc, 0, v20
s_cbranch_vccz L_pdone_q_9
s_cmp_gt_u32 s86, 200000
s_cbranch_scc1 L_pdone_q_9
s_branch L_poll_q_8
L_pdone_q_9:
v_add_f32 v64, v64, v72
v_add_f32 v80, v80, v88
v_add_f32 v64, v64, v80
v_add_f32 v66, v66, v74
v_add_f32 v82, v82, v90
v_add_f32 v66, v66, v82
v_add_f32 v68, v68, v76
v_add_f32 v84, v84, v92
v_add_f32 v68, v68, v84
v_add_f32 v70, v70, v78
v_add_f32 v86, v86, v94
v_add_f32 v70, v70, v86
v_cvt_pk_bf16_f32 v64, v64, v66
v_cvt_pk_bf16_f32 v65, v68, v70
s_lshl_b32 s60, s99, 9
s_add_u32 s60, s60, 2048
v_lshlrev_b32 v19, 2, v1
v_add_u32 v19, s60, v19
ds_write_b32 v19, v64
ds_write_b32 v19, v65 offset:256
s_waitcnt lgkmcnt(0)
s_mov_b64 exec, 1
v_mov_b32 v21, 1316
v_mov_b32 v22, 1
ds_add_u32 v21, v22
s_mov_b64 exec, -1
v_mov_b32 v21, 1316
s_mov_b32 s86, 0
L_spin_qrdy_10:
ds_read_b32 v2, v21
s_add_u32 s86, s86, 1
s_waitcnt lgkmcnt(0)
v_readfirstlane_b32 s60, v2
s_cmp_ge_u32 s60, 4
s_cbranch_scc1 L_done_qrdy_11
s_cmp_gt_u32 s86, 2000000
s_cbranch_scc1 L_done_qrdy_11
s_sleep 1
s_branch L_spin_qrdy_10
L_done_qrdy_11:
v_and_b32 v19, 7, v16
v_lshlrev_b32 v19, 8, v19
v_lshrrev_b32 v20, 3, v16
v_lshlrev_b32 v20, 6, v20
v_add_u32 v19, v19, v20
v_lshlrev_b32 v20, 4, v17
v_add_u32 v19, v19, v20
ds_read_b128 v[8:11], v19 offset:2048
ds_read_b128 v[12:15], v19 offset:2176
s_waitcnt lgkmcnt(0)
v_mfma_f32_16x16x32_bf16 v[64:67], v[128:131], v[8:11], 0
v_mfma_f32_16x16x32_bf16 v[64:67], v[132:135], v[12:15], v[64:67]
v_mfma_f32_16x16x32_bf16 v[68:71], v[136:139], v[8:11], 0
v_mfma_f32_16x16x32_bf16 v[68:71], v[140:143], v[12:15], v[68:71]
v_mfma_f32_16x16x32_bf16 v[72:75], v[144:147], v[8:11], 0
v_mfma_f32_16x16x32_bf16 v[72:75], v[148:151], v[12:15], v[72:75]
v_mfma_f32_16x16x32_bf16 v[76:79], v[152:155], v[8:11], 0
v_mfma_f32_16x16x32_bf16 v[76:79], v[156:159], v[12:15], v[76:79]
v_mfma_f32_16x16x32_bf16 v[96:99], v[160:163], v[8:11], 0
v_mfma_f32_16x16x32_bf16 v[96:99], v[164:167], v[12:15], v[96:99]
v_mfma_f32_16x16x32_bf16 v[100:103], v[168:171], v[8:11], 0
v_mfma_f32_16x16x32_bf16 v[100:103], v[172:175], v[12:15], v[100:103]
v_mfma_f32_16x16x32_bf16 v[104:107], v[176:179], v[8:11], 0
v_mfma_f32_16x16x32_bf16 v[104:107], v[180:183], v[12:15], v[104:107]
v_mfma_f32_16x16x32_bf16 v[108:111], v[184:187], v[8:11], 0
v_mfma_f32_16x16x32_bf16 v[108:111], v[188:191], v[12:15], v[108:111]
v_permlane32_swap_b32 v64, v72
v_permlane32_swap_b32 v65, v73
v_permlane32_swap_b32 v66, v74
v_permlane32_swap_b32 v67, v75
v_permlane32_swap_b32 v68, v76
v_permlane32_swap_b32 v69, v77
v_permlane32_swap_b32 v70, v78
v_permlane32_swap_b32 v71, v79
v_add_f32_dpp v32, v72, v64 row_ror:8 row_mask:0xf bank_mask:0xf
v_add_f32_dpp v33, v73, v65 row_ror:8 row_mask:0xf bank_mask:0xf
v_add_f32_dpp v34, v74, v66 row_ror:8 row_mask:0xf bank_mask:0xf
v_add_f32_dpp v35, v75, v67 row_ror:8 row_mask:0xf bank_mask:0xf
v_add_f32_dpp v36, v76, v68 row_ror:8 row_mask:0xf bank_mask:0xf
v_add_f32_dpp v37, v77, v69 row_ror:8 row_mask:0xf bank_mask:0xf
v_add_f32_dpp v38, v78, v70 row_ror:8 row_mask:0xf bank_mask:0xf
v_add_f32_dpp v39, v79, v71 row_ror:8 row_mask:0xf bank_mask:0xf
v_mfma_f32_16x16x32_bf16 v[64:67], v[192:195], v[8:11], 0
v_mfma_f32_16x16x32_bf16 v[64:67], v[196:199], v[12:15], v[64:67]
v_mfma_f32_16x16x32_bf16 v[68:71], v[200:203], v[8:11], 0
v_mfma_f32_16x16x32_bf16 v[68:71], v[204:207], v[12:15], v[68:71]
v_mfma_f32_16x16x32_bf16 v[72:75], v[208:211], v[8:11], 0
v_mfma_f32_16x16x32_bf16 v[72:75], v[212:215], v[12:15], v[72:75]
v_mfma_f32_16x16x32_bf16 v[76:79], v[216:219], v[8:11], 0
v_mfma_f32_16x16x32_bf16 v[76:79], v[220:223], v[12:15], v[76:79]
v_permlane32_swap_b32 v96, v104
v_permlane32_swap_b32 v97, v105
v_permlane32_swap_b32 v98, v106
v_permlane32_swap_b32 v99, v107
v_permlane32_swap_b32 v100, v108
v_permlane32_swap_b32 v101, v109
v_permlane32_swap_b32 v102, v110
v_permlane32_swap_b32 v103, v111
v_add_f32_dpp v40, v104, v96 row_ror:8 row_mask:0xf bank_mask:0xf
v_add_f32_dpp v41, v105, v97 row_ror:8 row_mask:0xf bank_mask:0xf
v_add_f32_dpp v42, v106, v98 row_ror:8 row_mask:0xf bank_mask:0xf
v_add_f32_dpp v43, v107, v99 row_ror:8 row_mask:0xf bank_mask:0xf
v_add_f32_dpp v44, v108, v100 row_ror:8 row_mask:0xf bank_mask:0xf
v_add_f32_dpp v45, v109, v101 row_ror:8 row_mask:0xf bank_mask:0xf
v_add_f32_dpp v46, v110, v102 row_ror:8 row_mask:0xf bank_mask:0xf
v_add_f32_dpp v47, v111, v103 row_ror:8 row_mask:0xf bank_mask:0xf
v_mfma_f32_16x16x32_bf16 v[96:99], v[224:227], v[8:11], 0
v_mfma_f32_16x16x32_bf16 v[96:99], v[228:231], v[12:15], v[96:99]
v_mfma_f32_16x16x32_bf16 v[100:103], v[232:235], v[8:11], 0
v_mfma_f32_16x16x32_bf16 v[100:103], v[236:239], v[12:15], v[100:103]
v_mfma_f32_16x16x32_bf16 v[104:107], v[240:243], v[8:11], 0
v_mfma_f32_16x16x32_bf16 v[104:107], v[244:247], v[12:15], v[104:107]
v_mfma_f32_16x16x32_bf16 v[108:111], v[248:251], v[8:11], 0
v_mfma_f32_16x16x32_bf16 v[108:111], v[252:255], v[12:15], v[108:111]
v_permlane32_swap_b32 v64, v72
v_permlane32_swap_b32 v65, v73
v_permlane32_swap_b32 v66, v74
v_permlane32_swap_b32 v67, v75
v_permlane32_swap_b32 v68, v76
v_permlane32_swap_b32 v69, v77
v_permlane32_swap_b32 v70, v78
v_permlane32_swap_b32 v71, v79
v_add_f32_dpp v48, v72, v64 row_ror:8 row_mask:0xf bank_mask:0xf
v_add_f32_dpp v49, v73, v65 row_ror:8 row_mask:0xf bank_mask:0xf
v_add_f32_dpp v50, v74, v66 row_ror:8 row_mask:0xf bank_mask:0xf
v_add_f32_dpp v51, v75, v67 row_ror:8 row_mask:0xf bank_mask:0xf
v_add_f32_dpp v52, v76, v68 row_ror:8 row_mask:0xf bank_mask:0xf
v_add_f32_dpp v53, v77, v69 row_ror:8 row_mask:0xf bank_mask:0xf
v_add_f32_dpp v54, v78, v70 row_ror:8 row_mask:0xf bank_mask:0xf
v_add_f32_dpp v55, v79, v71 row_ror:8 row_mask:0xf bank_mask:0xf
v_permlane32_swap_b32 v96, v104
v_permlane32_swap_b32 v97, v105
v_permlane32_swap_b32 v98, v106
v_permlane32_swap_b32 v99, v107
v_permlane32_swap_b32 v100, v108
v_permlane32_swap_b32 v101, v109
v_permlane32_swap_b32 v102, v110
v_permlane32_swap_b32 v103, v111
v_add_f32_dpp v56, v104, v96 row_ror:8 row_mask:0xf bank_mask:0xf
v_add_f32_dpp v57, v105, v97 row_ror:8 row_mask:0xf bank_mask:0xf
v_add_f32_dpp v58, v106, v98 row_ror:8 row_mask:0xf bank_mask:0xf
v_add_f32_dpp v59, v107, v99 row_ror:8 row_mask:0xf bank_mask:0xf
v_add_f32_dpp v60, v108, v100 row_ror:8 row_mask:0xf bank_mask:0xf
v_add_f32_dpp v61, v109, v101 row_ror:8 row_mask:0xf bank_mask:0xf
v_add_f32_dpp v62, v110, v102 row_ror:8 row_mask:0xf bank_mask:0xf
v_add_f32_dpp v63, v111, v103 row_ror:8 row_mask:0xf bank_mask:0xf
v_cvt_pk_bf16_f32 v64, v32, v33
v_lshlrev_b32 v32, 16, v64
v_and_b32 v33, 0xffff0000, v64
v_mul_f32 v32, 0x3db504f3, v32
v_mul_f32 v33, 0x3db504f3, v33
v_cvt_pk_bf16_f32 v65, v32, v33
v_lshlrev_b32 v32, 16, v65
v_and_b32 v33, 0xffff0000, v65
v_cvt_pk_bf16_f32 v64, v34, v35
v_lshlrev_b32 v34, 16, v64
v_and_b32 v35, 0xffff0000, v64
v_mul_f32 v34, 0x3db504f3, v34
v_mul_f32 v35, 0x3db504f3, v35
v_cvt_pk_bf16_f32 v65, v34, v35
v_lshlrev_b32 v34, 16, v65
v_and_b32 v35, 0xffff0000, v65
v_cvt_pk_bf16_f32 v64, v36, v37
v_lshlrev_b32 v36, 16, v64
v_and_b32 v37, 0xffff0000, v64
v_mul_f32 v36, 0x3db504f3, v36
v_mul_f32 v37, 0x3db504f3, v37
v_cvt_pk_bf16_f32 v65, v36, v37
v_lshlrev_b32 v36, 16, v65
v_and_b32 v37, 0xffff0000, v65
v_cvt_pk_bf16_f32 v64, v38, v39
v_lshlrev_b32 v38, 16, v64
v_and_b32 v39, 0xffff0000, v64
v_mul_f32 v38, 0x3db504f3, v38
v_mul_f32 v39, 0x3db504f3, v39
v_cvt_pk_bf16_f32 v65, v38, v39
v_lshlrev_b32 v38, 16, v65
v_and_b32 v39, 0xffff0000, v65
v_cvt_pk_bf16_f32 v64, v40, v41
v_lshlrev_b32 v40, 16, v64
v_and_b32 v41, 0xffff0000, v64
v_mul_f32 v40, 0x3db504f3, v40
v_mul_f32 v41, 0x3db504f3, v41
v_cvt_pk_bf16_f32 v65, v40, v41
v_lshlrev_b32 v40, 16, v65
v_and_b32 v41, 0xffff0000, v65
v_cvt_pk_bf16_f32 v64, v42, v43
v_lshlrev_b32 v42, 16, v64
v_and_b32 v43, 0xffff0000, v64
v_mul_f32 v42, 0x3db504f3, v42
v_mul_f32 v43, 0x3db504f3, v43
v_cvt_pk_bf16_f32 v65, v42, v43
v_lshlrev_b32 v42, 16, v65
v_and_b32 v43, 0xffff0000, v65
v_cvt_pk_bf16_f32 v64, v44, v45
v_lshlrev_b32 v44, 16, v64
v_and_b32 v45, 0xffff0000, v64
v_mul_f32 v44, 0x3db504f3, v44
v_mul_f32 v45, 0x3db504f3, v45
v_cvt_pk_bf16_f32 v65, v44, v45
v_lshlrev_b32 v44, 16, v65
v_and_b32 v45, 0xffff0000, v65
v_cvt_pk_bf16_f32 v64, v46, v47
v_lshlrev_b32 v46, 16, v64
v_and_b32 v47, 0xffff0000, v64
v_mul_f32 v46, 0x3db504f3, v46
v_mul_f32 v47, 0x3db504f3, v47
v_cvt_pk_bf16_f32 v65, v46, v47
v_lshlrev_b32 v46, 16, v65
v_and_b32 v47, 0xffff0000, v65
v_cvt_pk_bf16_f32 v64, v48, v49
v_lshlrev_b32 v48, 16, v64
v_and_b32 v49, 0xffff0000, v64
v_mul_f32 v48, 0x3db504f3, v48
v_mul_f32 v49, 0x3db504f3, v49
v_cvt_pk_bf16_f32 v65, v48, v49
v_lshlrev_b32 v48, 16, v65
v_and_b32 v49, 0xffff0000, v65
v_cvt_pk_bf16_f32 v64, v50, v51
v_lshlrev_b32 v50, 16, v64
v_and_b32 v51, 0xffff0000, v64
v_mul_f32 v50, 0x3db504f3, v50
v_mul_f32 v51, 0x3db504f3, v51
v_cvt_pk_bf16_f32 v65, v50, v51
v_lshlrev_b32 v50, 16, v65
v_and_b32 v51, 0xffff0000, v65
v_cvt_pk_bf16_f32 v64, v52, v53
v_lshlrev_b32 v52, 16, v64
v_and_b32 v53, 0xffff0000, v64
v_mul_f32 v52, 0x3db504f3, v52
v_mul_f32 v53, 0x3db504f3, v53
v_cvt_pk_bf16_f32 v65, v52, v53
v_lshlrev_b32 v52, 16, v65
v_and_b32 v53, 0xffff0000, v65
v_cvt_pk_bf16_f32 v64, v54, v55
v_lshlrev_b32 v54, 16, v64
v_and_b32 v55, 0xffff0000, v64
v_mul_f32 v54, 0x3db504f3, v54
v_mul_f32 v55, 0x3db504f3, v55
v_cvt_pk_bf16_f32 v65, v54, v55
v_lshlrev_b32 v54, 16, v65
v_and_b32 v55, 0xffff0000, v65
v_cvt_pk_bf16_f32 v64, v56, v57
v_lshlrev_b32 v56, 16, v64
v_and_b32 v57, 0xffff0000, v64
v_mul_f32 v56, 0x3db504f3, v56
v_mul_f32 v57, 0x3db504f3, v57
v_cvt_pk_bf16_f32 v65, v56, v57
v_lshlrev_b32 v56, 16, v65
v_and_b32 v57, 0xffff0000, v65
v_cvt_pk_bf16_f32 v64, v58, v59
v_lshlrev_b32 v58, 16, v64
v_and_b32 v59, 0xffff0000, v64
v_mul_f32 v58, 0x3db504f3, v58
v_mul_f32 v59, 0x3db504f3, v59
v_cvt_pk_bf16_f32 v65, v58, v59
v_lshlrev_b32 v58, 16, v65
v_and_b32 v59, 0xffff0000, v65
v_cvt_pk_bf16_f32 v64, v60, v61
v_lshlrev_b32 v60, 16, v64
v_and_b32 v61, 0xffff0000, v64
v_mul_f32 v60, 0x3db504f3, v60
v_mul_f32 v61, 0x3db504f3, v61
v_cvt_pk_bf16_f32 v65, v60, v61
v_lshlrev_b32 v60, 16, v65
v_and_b32 v61, 0xffff0000, v65
v_cvt_pk_bf16_f32 v64, v62, v63
v_lshlrev_b32 v62, 16, v64
v_and_b32 v63, 0xffff0000, v64
v_mul_f32 v62, 0x3db504f3, v62
v_mul_f32 v63, 0x3db504f3, v63
v_cvt_pk_bf16_f32 v65, v62, v63
v_lshlrev_b32 v62, 16, v65
v_and_b32 v63, 0xffff0000, v65
v_max3_f32 v64, v32, v33, v34
v_max3_f32 v64, v64, v35, v36
v_max3_f32 v64, v64, v37, v38
v_max3_f32 v64, v64, v39, v40
v_max3_f32 v64, v64, v41, v42
v_max3_f32 v64, v64, v43, v44
v_max3_f32 v64, v64, v45, v46
v_max3_f32 v64, v64, v47, v48
v_max3_f32 v64, v64, v49, v50
v_max3_f32 v64, v64, v51, v52
v_max3_f32 v64, v64, v53, v54
v_max3_f32 v64, v64, v55, v56
v_max3_f32 v64, v64, v57, v58
v_max3_f32 v64, v64, v59, v60
v_max3_f32 v64, v64, v61, v62
v_max_f32 v64, v64, v63
v_mov_b32 v65, v64
s_nop 1
v_permlane16_swap_b32 v64, v65
v_max_f32 v64, v64, v65
v_mov_b32 v65, v64
s_nop 1
v_permlane32_swap_b32 v64, v65
v_max_f32 v64, v64, v65
s_mov_b32 s68, 0x3fb8aa3b
v_mul_f32 v65, s68, v64
v_fma_f32 v32, v32, s68, -v65
v_fma_f32 v33, v33, s68, -v65
v_fma_f32 v34, v34, s68, -v65
v_fma_f32 v35, v35, s68, -v65
v_fma_f32 v36, v36, s68, -v65
v_fma_f32 v37, v37, s68, -v65
v_fma_f32 v38, v38, s68, -v65
v_fma_f32 v39, v39, s68, -v65
v_fma_f32 v40, v40, s68, -v65
v_fma_f32 v41, v41, s68, -v65
v_fma_f32 v42, v42, s68, -v65
v_fma_f32 v43, v43, s68, -v65
v_fma_f32 v44, v44, s68, -v65
v_fma_f32 v45, v45, s68, -v65
v_fma_f32 v46, v46, s68, -v65
v_fma_f32 v47, v47, s68, -v65
v_fma_f32 v48, v48, s68, -v65
v_fma_f32 v49, v49, s68, -v65
v_fma_f32 v50, v50, s68, -v65
v_fma_f32 v51, v51, s68, -v65
v_fma_f32 v52, v52, s68, -v65
v_fma_f32 v53, v53, s68, -v65
v_fma_f32 v54, v54, s68, -v65
v_fma_f32 v55, v55, s68, -v65
v_fma_f32 v56, v56, s68, -v65
v_fma_f32 v57, v57, s68, -v65
v_fma_f32 v58, v58, s68, -v65
v_fma_f32 v59, v59, s68, -v65
v_fma_f32 v60, v60, s68, -v65
v_fma_f32 v61, v61, s68, -v65
v_fma_f32 v62, v62, s68, -v65
v_fma_f32 v63, v63, s68, -v65
v_exp_f32 v32, v32
v_exp_f32 v33, v33
v_exp_f32 v34, v34
v_exp_f32 v35, v35
v_exp_f32 v36, v36
v_exp_f32 v37, v37
v_exp_f32 v38, v38
v_exp_f32 v39, v39
v_exp_f32 v40, v40
v_exp_f32 v41, v41
v_exp_f32 v42, v42
v_exp_f32 v43, v43
v_exp_f32 v44, v44
v_exp_f32 v45, v45
v_exp_f32 v46, v46
v_exp_f32 v47, v47
v_exp_f32 v48, v48
v_exp_f32 v49, v49
v_exp_f32 v50, v50
v_exp_f32 v51, v51
v_exp_f32 v52, v52
v_exp_f32 v53, v53
v_exp_f32 v54, v54
v_exp_f32 v55, v55
v_exp_f32 v56, v56
v_exp_f32 v57, v57
v_exp_f32 v58, v58
v_exp_f32 v59, v59
v_exp_f32 v60, v60
v_exp_f32 v61, v61
v_exp_f32 v62, v62
v_exp_f32 v63, v63
v_add_f32 v66, v32, v33
v_add_f32 v67, v34, v35
v_add_f32 v66, v66, v67
v_add_f32 v67, v36, v37
v_add_f32 v66, v66, v67
v_add_f32 v67, v38, v39
v_add_f32 v66, v66, v67
v_add_f32 v67, v40, v41
v_add_f32 v66, v66, v67
v_add_f32 v67, v42, v43
v_add_f32 v66, v66, v67
v_add_f32 v67, v44, v45
v_add_f32 v66, v66, v67
v_add_f32 v67, v46, v47
v_add_f32 v66, v66, v67
v_add_f32 v67, v48, v49
v_add_f32 v66, v66, v67
v_add_f32 v67, v50, v51
v_add_f32 v66, v66, v67
v_add_f32 v67, v52, v53
v_add_f32 v66, v66, v67
v_add_f32 v67, v54, v55
v_add_f32 v66, v66, v67
v_add_f32 v67, v56, v57
v_add_f32 v66, v66, v67
v_add_f32 v67, v58, v59
v_add_f32 v66, v66, v67
v_add_f32 v67, v60, v61
v_add_f32 v66, v66, v67
v_add_f32 v67, v62, v63
v_add_f32 v66, v66, v67
v_mov_b32 v67, v66
s_nop 1
v_permlane16_swap_b32 v66, v67
v_add_f32 v66, v66, v67
v_mov_b32 v67, v66
s_nop 1
v_permlane32_swap_b32 v66, v67
v_add_f32 v66, v66, v67
s_lshl_b32 s60, s99, 12
s_add_u32 s60, s60, 4096
v_lshlrev_b32 v20, 4, v1
v_add_u32 v20, s60, v20
v_cvt_pk_bf16_f32 v68, v32, v33
v_cvt_pk_bf16_f32 v69, v34, v35
v_cvt_pk_bf16_f32 v70, v36, v37
v_cvt_pk_bf16_f32 v71, v38, v39
ds_write_b128 v20, v[68:71] offset:0
v_cvt_pk_bf16_f32 v72, v40, v41
v_cvt_pk_bf16_f32 v73, v42, v43
v_cvt_pk_bf16_f32 v74, v44, v45
v_cvt_pk_bf16_f32 v75, v46, v47
ds_write_b128 v20, v[72:75] offset:1024
v_cvt_pk_bf16_f32 v76, v48, v49
v_cvt_pk_bf16_f32 v77, v50, v51
v_cvt_pk_bf16_f32 v78, v52, v53
v_cvt_pk_bf16_f32 v79, v54, v55
ds_write_b128 v20, v[76:79] offset:2048
v_cvt_pk_bf16_f32 v80, v56, v57
v_cvt_pk_bf16_f32 v81, v58, v59
v_cvt_pk_bf16_f32 v82, v60, v61
v_cvt_pk_bf16_f32 v83, v62, v63
ds_write_b128 v20, v[80:83] offset:3072
s_lshl_b32 s60, s99, 6
s_add_u32 s60, s60, 21504
v_lshlrev_b32 v19, 3, v1
v_add_u32 v19, s60, v19
v_mov_b32 v84, v64
v_mov_b32 v85, v66
s_mov_b64 exec, 0xff
ds_write_b64 v19, v[84:85]
s_mov_b64 exec, -1
s_lshl_b32 s60, s99, 2
s_add_u32 s60, s60, 1296
v_mov_b32 v23, s60
v_mov_b32 v22, 1
v_mov_b32 v21, 1320
s_waitcnt lgkmcnt(0)
ds_write_b32 v23, v22
s_mov_b64 exec, 1
ds_add_u32 v21, v22
s_mov_b64 exec, -1
s_mov_b32 s86, 0
L_spin_scnt_12:
ds_read_b32 v2, v21
s_add_u32 s86, s86, 1
s_waitcnt lgkmcnt(0)
v_readfirstlane_b32 s60, v2
s_cmp_ge_u32 s60, 4
s_cbranch_scc1 L_done_scnt_13
s_cmp_gt_u32 s86, 2000000
s_cbranch_scc1 L_done_scnt_13
s_sleep 1
s_branch L_spin_scnt_12
L_done_scnt_13:
v_and_b32 v19, 7, v1
v_lshlrev_b32 v19, 3, v19
ds_read_b64 v[68:69], v19 offset:21504
ds_read_b64 v[70:71], v19 offset:21568
ds_read_b64 v[72:73], v19 offset:21632
ds_read_b64 v[74:75], v19 offset:21696
s_waitcnt lgkmcnt(0)
v_mov_b32 v32, v68
v_mov_b32 v33, v70
v_mov_b32 v34, v72
v_mov_b32 v35, v74
v_max3_f32 v76, v68, v70, v72
v_max_f32 v76, v76, v74
v_sub_f32 v68, v68, v76
v_mul_f32 v68, s68, v68
v_sub_f32 v70, v70, v76
v_mul_f32 v70, s68, v70
v_sub_f32 v72, v72, v76
v_mul_f32 v72, s68, v72
v_sub_f32 v74, v74, v76
v_mul_f32 v74, s68, v74
v_exp_f32 v68, v68
v_exp_f32 v70, v70
v_exp_f32 v72, v72
v_exp_f32 v74, v74
v_mul_f32 v77, v68, v69
v_fmac_f32 v77, v70, v71
v_fmac_f32 v77, v72, v73
v_fmac_f32 v77, v74, v75
s_cmp_lg_u32 s99, 0
s_cbranch_scc1 L_nostat_14
v_mov_b32 v80, v76
v_mov_b32 v81, v77
v_mov_b32_dpp v82, v76 quad_perm:[1,0,3,2] row_mask:0xf bank_mask:0xf
v_mov_b32_dpp v83, v77 quad_perm:[1,0,3,2] row_mask:0xf bank_mask:0xf
v_bfi_b32 v80, s87, v4, v80
v_bfi_b32 v81, s87, v5, v81
v_bfi_b32 v82, s87, v6, v82
v_bfi_b32 v83, s87, v7, v83
s_lshl_b32 s60, s91, 5
s_add_u32 s60, s60, s90
s_lshl_b32 s60, s60, 7
s_add_u32 s60, s60, 0x4000
v_lshlrev_b32 v19, 3, v1
s_mov_b64 exec, 0x5555
buffer_store_dwordx4 v[80:83], v19, s[52:55], s60 offen sc1
s_mov_b64 exec, -1
L_nostat_14:
s_lshl_b32 s60, s91, 5
s_add_u32 s60, s60, s90
s_mul_i32 s60, s60, 4352
s_lshl_b32 s61, s99, 10
s_add_u32 s60, s60, s61
s_add_u32 s60, s60, 0x50000
v_lshlrev_b32 v23, 4, v1
v_add_u32 v58, s60, v23
s_lshl_b32 s60, s99, 10
s_add_u32 s60, s60, 4096
v_add_u32 v57, s60, v23
s_lshr_b32 s60, s2, 5
s_lshl_b32 s60, s60, 3
s_add_u32 s97, s60, s91
s_lshr_b32 s62, s2, 3
s_mul_i32 s64, s62, 37
s_lshr_b32 s64, s64, 8
s_lshl_b32 s64, s64, 3
s_add_u32 s96, s64, s91
s_lshr_b32 s60, s2, 4
s_lshl_b32 s60, s60, 3
s_add_u32 s101, s60, s91
s_lshr_b32 s38, s99, 1
s_and_b32 s39, s99, 1
s_lshr_b32 s60, s97, 4
s_lshl_b32 s61, s38, 2
s_add_u32 s60, s60, s61
s_mul_i32 s60, s60, 139264
s_bfe_u32 s61, s97, 0x20001
s_lshl_b32 s61, s61, 10
s_add_u32 s60, s60, s61
s_bfe_u32 s61, s97, 0x10003
s_lshl_b32 s61, s61, 8
s_add_u32 s60, s60, s61
s_and_b32 s61, s97, 1
s_lshl_b32 s61, s61, 9
s_add_u32 s60, s60, s61
s_lshl_b32 s61, s39, 7
s_add_u32 s60, s60, s61
s_add_u32 s60, s60, 0x50000
v_lshrrev_b32 v24, 3, v1
v_mul_u32_u24 v24, 4352, v24
v_and_b32 v22, 7, v1
v_lshlrev_b32 v22, 4, v22
v_add_u32 v24, v24, v22
v_add_u32 v24, s60, v24
v_and_b32 v25, 1, v17
v_lshlrev_b32 v25, 1, v25
v_lshrrev_b32 v26, 1, v17
v_or_b32 v25, v25, v26
v_lshlrev_b32 v26, 6, v25
v_lshrrev_b32 v27, 2, v22
v_add_u32 v26, v26, v27
s_lshl_b32 s60, s38, 8
s_lshl_b32 s61, s39, 5
s_add_u32 s60, s60, s61
v_add_u32 v26, s60, v26
v_and_b32 v52, 3, v1
v_lshlrev_b32 v52, 2, v52
v_add_u32 v52, v52, v25
s_lshl_b32 s60, s39, 4
v_add_u32 v52, s60, v52
s_mov_b32 s44, s16
s_mov_b32 s45, s17
s_mov_b32 s46, 0x1000
s_mov_b32 s47, 0x20000
s_lshl_b32 s60, s38, 11
s_lshl_b32 s61, s96, 6
s_add_u32 s60, s60, s61
v_lshlrev_b32 v53, 1, v52
v_add_u32 v53, s60, v53
buffer_load_ushort v54, v53, s[44:47], 0 offen
s_lshl_b32 s60, s38, 2
v_mov_b32 v55, s60
ds_read_b32 v55, v55 offset:25600
v_lshlrev_b32 v56, 2, v52
s_lshl_b32 s60, s38, 7
v_add_u32 v56, s60, v56
s_lshl_b32 s60, s91, 12
s_add_u32 s60, s60, 0x4000
v_lshrrev_b32 v19, 3, v1
v_lshlrev_b32 v19, 7, v19
v_bfe_u32 v20, v1, 1, 2
v_lshlrev_b32 v20, 4, v20
v_add_u32 v19, v19, v20
v_add_u32 v19, s60, v19
s_lshl_b32 s60, s99, 2
s_add_u32 s60, s60, 1328
v_mov_b32 v21, s60
s_mov_b32 s86, 0
L_spin_viss_15:
ds_read_b32 v2, v21
s_add_u32 s86, s86, 1
s_waitcnt lgkmcnt(0)
v_readfirstlane_b32 s60, v2
s_cmp_ge_u32 s60, 1
s_cbranch_scc1 L_done_viss_16
s_cmp_gt_u32 s86, 2000000
s_cbranch_scc1 L_done_viss_16
s_sleep 1
s_branch L_spin_viss_15
L_done_viss_16:
s_mov_b32 s86, 0
s_sleep 8
buffer_load_dwordx4 v[80:83], v19, s[52:55], 0 offen offset:0 sc1
buffer_load_dwordx4 v[84:87], v19, s[52:55], 0 offen offset:1024 sc1
buffer_load_dwordx4 v[88:91], v19, s[52:55], 0 offen offset:2048 sc1
buffer_load_dwordx4 v[92:95], v19, s[52:55], 0 offen offset:3072 sc1
s_lshl_b32 s60, s99, 2
s_add_u32 s60, s60, 1344
v_mov_b32 v21, s60
v_mov_b32 v22, 1
ds_write_b32 v21, v22
s_waitcnt vmcnt(0)
v_xor_b32 v78, v80, v4
v_bitop3_b32 v78, v78, v81, v5 bitop3:0xf6
v_bitop3_b32 v78, v78, v82, v6 bitop3:0xf6
v_bitop3_b32 v78, v78, v83, v7 bitop3:0xf6
v_bitop3_b32 v78, v78, v84, v4 bitop3:0xf6
v_bitop3_b32 v78, v78, v85, v5 bitop3:0xf6
v_bitop3_b32 v78, v78, v86, v6 bitop3:0xf6
v_bitop3_b32 v78, v78, v87, v7 bitop3:0xf6
v_bitop3_b32 v78, v78, v88, v4 bitop3:0xf6
v_bitop3_b32 v78, v78, v89, v5 bitop3:0xf6
v_bitop3_b32 v78, v78, v90, v6 bitop3:0xf6
v_bitop3_b32 v78, v78, v91, v7 bitop3:0xf6
v_bitop3_b32 v78, v78, v92, v4 bitop3:0xf6
v_bitop3_b32 v78, v78, v93, v5 bitop3:0xf6
v_bitop3_b32 v78, v78, v94, v6 bitop3:0xf6
v_bitop3_b32 v78, v78, v95, v7 bitop3:0xf6
v_and_b32 v78, s87, v78
v_cmp_ne_u32 vcc, 0, v78
s_cbranch_vccz L_pdone_stat_18
L_poll_stat_17:
buffer_load_dwordx4 v[80:83], v19, s[52:55], 0 offen offset:0 sc1
buffer_load_dwordx4 v[84:87], v19, s[52:55], 0 offen offset:1024 sc1
buffer_load_dwordx4 v[88:91], v19, s[52:55], 0 offen offset:2048 sc1
buffer_load_dwordx4 v[92:95], v19, s[52:55], 0 offen offset:3072 sc1
s_add_u32 s86, s86, 1
s_waitcnt vmcnt(0)
v_xor_b32 v78, v80, v4
v_bitop3_b32 v78, v78, v81, v5 bitop3:0xf6
v_bitop3_b32 v78, v78, v82, v6 bitop3:0xf6
v_bitop3_b32 v78, v78, v83, v7 bitop3:0xf6
v_bitop3_b32 v78, v78, v84, v4 bitop3:0xf6
v_bitop3_b32 v78, v78, v85, v5 bitop3:0xf6
v_bitop3_b32 v78, v78, v86, v6 bitop3:0xf6
v_bitop3_b32 v78, v78, v87, v7 bitop3:0xf6
v_bitop3_b32 v78, v78, v88, v4 bitop3:0xf6
v_bitop3_b32 v78, v78, v89, v5 bitop3:0xf6
v_bitop3_b32 v78, v78, v90, v6 bitop3:0xf6
v_bitop3_b32 v78, v78, v91, v7 bitop3:0xf6
v_bitop3_b32 v78, v78, v92, v4 bitop3:0xf6
v_bitop3_b32 v78, v78, v93, v5 bitop3:0xf6
v_bitop3_b32 v78, v78, v94, v6 bitop3:0xf6
v_bitop3_b32 v78, v78, v95, v7 bitop3:0xf6
v_and_b32 v78, s87, v78
v_cmp_ne_u32 vcc, 0, v78
s_cbranch_vccz L_pdone_stat_18
s_cmp_gt_u32 s86, 200000
s_cbranch_scc1 L_pdone_stat_18
s_sleep 8
s_branch L_poll_stat_17
L_pdone_stat_18:
v_and_b32 v20, 1, v1
v_cmp_eq_u32 vcc, 1, v20
s_not_b32 s60, s87
s_nop 0
v_cndmask_b32 v80, v80, v82, vcc
v_cndmask_b32 v81, v81, v83, vcc
v_and_b32 v80, s60, v80
v_cndmask_b32 v84, v84, v86, vcc
v_cndmask_b32 v85, v85, v87, vcc
v_and_b32 v84, s60, v84
v_cndmask_b32 v88, v88, v90, vcc
v_cndmask_b32 v89, v89, v91, vcc
v_and_b32 v88, s60, v88
v_cndmask_b32 v92, v92, v94, vcc
v_cndmask_b32 v93, v93, v95, vcc
v_and_b32 v92, s60, v92
v_max3_f32 v78, v80, v84, v88
v_max_f32 v78, v78, v92
s_nop 1
v_max_f32_dpp v78, v78, v78 row_ror:8 row_mask:0xf bank_mask:0xf
v_mov_b32 v79, v78
s_nop 1
v_permlane16_swap_b32 v78, v79
v_max_f32 v78, v78, v79
v_mov_b32 v79, v78
s_nop 1
v_permlane32_swap_b32 v78, v79
v_max_f32 v78, v78, v79
v_sub_f32 v80, v80, v78
v_mul_f32 v80, s68, v80
v_sub_f32 v84, v84, v78
v_mul_f32 v84, s68, v84
v_sub_f32 v88, v88, v78
v_mul_f32 v88, s68, v88
v_sub_f32 v92, v92, v78
v_mul_f32 v92, s68, v92
v_sub_f32 v32, v32, v78
v_mul_f32 v32, s68, v32
v_sub_f32 v33, v33, v78
v_mul_f32 v33, s68, v33
v_sub_f32 v34, v34, v78
v_mul_f32 v34, s68, v34
v_sub_f32 v35, v35, v78
v_mul_f32 v35, s68, v35
v_exp_f32 v80, v80
v_exp_f32 v84, v84
v_exp_f32 v88, v88
v_exp_f32 v92, v92
v_exp_f32 v32, v32
v_exp_f32 v33, v33
v_exp_f32 v34, v34
v_exp_f32 v35, v35
v_mul_f32 v79, v80, v81
v_fmac_f32 v79, v84, v85
v_fmac_f32 v79, v88, v89
v_fmac_f32 v79, v92, v93
s_nop 1
v_add_f32_dpp v79, v79, v79 row_ror:8 row_mask:0xf bank_mask:0xf
v_mov_b32 v80, v79
s_nop 1
v_permlane16_swap_b32 v79, v80
v_add_f32 v79, v79, v80
v_mov_b32 v80, v79
s_nop 1
v_permlane32_swap_b32 v79, v80
v_add_f32 v79, v79, v80
v_rcp_f32 v65, v79
s_nop 0
v_fma_f32 v66, -v79, v65, 1.0
v_fma_f32 v65, v66, v65, v65
v_mul_f32 v32, v32, v65
v_mul_f32 v33, v33, v65
v_mul_f32 v34, v34, v65
v_mul_f32 v35, v35, v65
s_lshl_b32 s60, s99, 7
s_add_u32 s60, s60, 20480
v_and_b32 v19, 7, v1
v_lshlrev_b32 v19, 2, v19
v_add_u32 v19, s60, v19
ds_write_b32 v19, v32 offset:0
ds_write_b32 v19, v33 offset:32
ds_write_b32 v19, v34 offset:64
ds_write_b32 v19, v35 offset:96
v_and_b32 v19, 1, v17
v_lshlrev_b32 v19, 4, v19
v_add_u32 v19, s60, v19
s_waitcnt lgkmcnt(0)
ds_read_b128 v[36:39], v19 offset:0
ds_read_b128 v[40:43], v19 offset:32
ds_read_b128 v[44:47], v19 offset:64
ds_read_b128 v[48:51], v19 offset:96
s_barrier
ds_read_b128 v[64:67], v57 offset:0
ds_read_b128 v[68:71], v57 offset:4096
ds_read_b128 v[72:75], v57 offset:8192
ds_read_b128 v[76:79], v57 offset:12288
s_waitcnt lgkmcnt(0)
v_mul_f32 v64, v64, v36
v_mul_f32 v65, v65, v37
v_mul_f32 v66, v66, v38
v_mul_f32 v67, v67, v39
v_fmac_f32 v64, v68, v40
v_fmac_f32 v65, v69, v41
v_fmac_f32 v66, v70, v42
v_fmac_f32 v67, v71, v43
v_fmac_f32 v64, v72, v44
v_fmac_f32 v65, v73, v45
v_fmac_f32 v66, v74, v46
v_fmac_f32 v67, v75, v47
v_fmac_f32 v64, v76, v48
v_fmac_f32 v65, v77, v49
v_fmac_f32 v66, v78, v50
v_fmac_f32 v67, v79, v51
v_bfi_b32 v64, s87, v4, v64
v_bfi_b32 v65, s87, v5, v65
v_bfi_b32 v66, s87, v6, v66
v_bfi_b32 v67, s87, v7, v67
buffer_store_dwordx4 v[64:67], v58, s[52:55], 0 offen sc1
s_barrier
s_mov_b32 s86, 0
s_sleep 30
L_poll_h2_19:
buffer_load_dwordx4 v[80:83], v24, s[52:55], 0 offen offset:0 sc1
s_mov_b32 s63, 34816
buffer_load_dwordx4 v[84:87], v24, s[52:55], s63 offen sc1
s_mov_b32 s63, 69632
buffer_load_dwordx4 v[88:91], v24, s[52:55], s63 offen sc1
s_mov_b32 s63, 104448
buffer_load_dwordx4 v[92:95], v24, s[52:55], s63 offen sc1
s_add_u32 s86, s86, 1
s_waitcnt vmcnt(0)
v_xor_b32 v78, v80, v4
v_bitop3_b32 v78, v78, v81, v5 bitop3:0xf6
v_bitop3_b32 v78, v78, v82, v6 bitop3:0xf6
v_bitop3_b32 v78, v78, v83, v7 bitop3:0xf6
v_bitop3_b32 v78, v78, v84, v4 bitop3:0xf6
v_bitop3_b32 v78, v78, v85, v5 bitop3:0xf6
v_bitop3_b32 v78, v78, v86, v6 bitop3:0xf6
v_bitop3_b32 v78, v78, v87, v7 bitop3:0xf6
v_bitop3_b32 v78, v78, v88, v4 bitop3:0xf6
v_bitop3_b32 v78, v78, v89, v5 bitop3:0xf6
v_bitop3_b32 v78, v78, v90, v6 bitop3:0xf6
v_bitop3_b32 v78, v78, v91, v7 bitop3:0xf6
v_bitop3_b32 v78, v78, v92, v4 bitop3:0xf6
v_bitop3_b32 v78, v78, v93, v5 bitop3:0xf6
v_bitop3_b32 v78, v78, v94, v6 bitop3:0xf6
v_bitop3_b32 v78, v78, v95, v7 bitop3:0xf6
v_and_b32 v78, s87, v78
v_cmp_ne_u32 vcc, 0, v78
s_cbranch_vccz L_pdone_h2_20
s_cmp_gt_u32 s86, 200000
s_cbranch_scc1 L_pdone_h2_20
s_branch L_poll_h2_19
L_pdone_h2_20:
v_add_f32 v80, v80, v84
v_add_f32 v88, v88, v92
v_add_f32 v81, v81, v85
v_add_f32 v89, v89, v93
v_add_f32 v82, v82, v86
v_add_f32 v90, v90, v94
v_add_f32 v83, v83, v87
v_add_f32 v91, v91, v95
v_add_f32 v80, v80, v88
v_add_f32 v81, v81, v89
v_add_f32 v82, v82, v90
v_add_f32 v83, v83, v91
v_permlane32_swap_b32 v80, v81
s_nop 0
v_permlane32_swap_b32 v82, v83
v_add_f32 v80, v80, v81
v_add_f32 v82, v82, v83
s_nop 1
v_permlane16_swap_b32 v80, v82
v_add_f32 v80, v80, v82
s_nop 1
v_add_f32_dpp v80, v80, v80 row_ror:8 row_mask:0xf bank_mask:0xf
v_cvt_pk_bf16_f32 v80, v80, v80
s_mov_b32 s60, 0x00ff00ff
s_mov_b32 s61, 0x00ff00ff
s_mov_b64 exec, s[60:61]
ds_write_b32 v26, v80 offset:24576
s_mov_b64 exec, -1
s_lshr_b32 s60, s96, 3
s_mul_i32 s60, s60, 2304
s_and_b32 s61, s96, 7
s_lshl_b32 s61, s61, 8
s_add_u32 s60, s60, s61
s_lshl_b32 s61, s99, 6
s_add_u32 s60, s60, s61
s_add_u32 s60, s60, 0x170000
v_lshrrev_b32 v27, 2, v1
v_and_b32 v22, 3, v1
v_lshlrev_b32 v22, 4, v22
v_mul_u32_u24 v24, 9216, v27
v_add_u32 v24, v24, v22
v_add_u32 v24, s60, v24
v_lshlrev_b32 v54, 16, v54
s_waitcnt lgkmcnt(0)
s_barrier
s_barrier
s_barrier
s_barrier
s_mov_b32 s26, 0x000f000f
s_mov_b32 s27, 0x000f000f
s_cmp_ge_u32 s2, 224
s_cbranch_scc1 L_skip3_21
s_mov_b32 s86, 0
s_sleep 25
L_poll_h3_22:
buffer_load_dwordx4 v[80:83], v24, s[52:55], 0 offen offset:0 sc1
s_mov_b32 s63, 147456
buffer_load_dwordx4 v[84:87], v24, s[52:55], s63 offen sc1
s_mov_b32 s63, 294912
buffer_load_dwordx4 v[88:91], v24, s[52:55], s63 offen sc1
s_mov_b32 s63, 442368
buffer_load_dwordx4 v[92:95], v24, s[52:55], s63 offen sc1
s_add_u32 s86, s86, 1
s_waitcnt vmcnt(0)
v_xor_b32 v78, v80, v4
v_bitop3_b32 v78, v78, v81, v5 bitop3:0xf6
v_bitop3_b32 v78, v78, v82, v6 bitop3:0xf6
v_bitop3_b32 v78, v78, v83, v7 bitop3:0xf6
v_bitop3_b32 v78, v78, v84, v4 bitop3:0xf6
v_bitop3_b32 v78, v78, v85, v5 bitop3:0xf6
v_bitop3_b32 v78, v78, v86, v6 bitop3:0xf6
v_bitop3_b32 v78, v78, v87, v7 bitop3:0xf6
v_bitop3_b32 v78, v78, v88, v4 bitop3:0xf6
v_bitop3_b32 v78, v78, v89, v5 bitop3:0xf6
v_bitop3_b32 v78, v78, v90, v6 bitop3:0xf6
v_bitop3_b32 v78, v78, v91, v7 bitop3:0xf6
v_bitop3_b32 v78, v78, v92, v4 bitop3:0xf6
v_bitop3_b32 v78, v78, v93, v5 bitop3:0xf6
v_bitop3_b32 v78, v78, v94, v6 bitop3:0xf6
v_bitop3_b32 v78, v78, v95, v7 bitop3:0xf6
v_and_b32 v78, s87, v78
v_cmp_ne_u32 vcc, 0, v78
s_cbranch_vccz L_pdone_h3_23
s_cmp_gt_u32 s86, 200000
s_cbranch_scc1 L_pdone_h3_23
s_branch L_poll_h3_22
L_pdone_h3_23:
v_add_f32 v80, v80, v84
v_add_f32 v88, v88, v92
v_add_f32 v81, v81, v85
v_add_f32 v89, v89, v93
v_add_f32 v82, v82, v86
v_add_f32 v90, v90, v94
v_add_f32 v83, v83, v87
v_add_f32 v91, v91, v95
v_add_f32 v80, v80, v88
v_add_f32 v81, v81, v89
v_add_f32 v82, v82, v90
v_add_f32 v83, v83, v91
v_permlane32_swap_b32 v80, v81
s_nop 0
v_permlane32_swap_b32 v82, v83
v_add_f32 v80, v80, v81
v_add_f32 v82, v82, v83
s_nop 1
v_permlane16_swap_b32 v80, v82
v_add_f32 v80, v80, v82
s_nop 1
v_add_f32_dpp v80, v80, v80 row_ror:8 row_mask:0xf bank_mask:0xf
s_nop 1
v_add_f32_dpp v80, v80, v80 row_ror:4 row_mask:0xf bank_mask:0xf
v_cvt_pk_bf16_f32 v80, v80, v80
v_lshlrev_b32 v80, 16, v80
v_add_f32 v80, v80, v54
v_cvt_pk_bf16_f32 v80, v80, v80
s_mov_b64 exec, s[26:27]
ds_write_b32 v56, v80 offset:25088
s_mov_b64 exec, -1
L_skip3_21:
s_lshr_b32 s60, s101, 4
s_mul_i32 s60, s60, 7424
s_add_u32 s60, s60, 0x210000
v_mul_u32_u24 v27, 51968, v27
v_add_u32 v27, s60, v27
s_and_b32 s61, s101, 15
s_mul_i32 s61, s61, 384
v_add_u32 v29, s61, v27
v_add_u32 v29, v29, v22
s_lshl_b32 s60, s99, 6
v_add_u32 v24, s60, v29
s_lshl_b32 s60, s39, 6
s_add_u32 s60, s60, 256
v_add_u32 v29, s60, v29
v_add_u32 v27, 6144, v27
s_waitcnt lgkmcnt(0)
s_barrier
s_cmp_ge_u32 s2, 224
s_cbranch_scc1 L_fin
s_cmp_lg_u32 s99, 0
s_cbranch_scc1 L_nostat2_24
v_lshlrev_b32 v64, 2, v1
ds_read_b32 v65, v64 offset:25088
v_lshrrev_b32 v66, 5, v1
v_lshlrev_b32 v66, 2, v66
ds_read_b32 v66, v66 offset:25600
s_lshr_b32 s62, s2, 3
s_mul_i32 s64, s62, 37
s_lshr_b32 s64, s64, 8
s_mul_i32 s65, s64, 7
s_sub_u32 s65, s62, s65
s_mul_i32 s60, s96, 7
s_add_u32 s60, s60, s65
s_mul_i32 s60, s60, 7424
s_add_u32 s60, s60, 0x211800
s_waitcnt lgkmcnt(0)
v_and_b32 v65, 0xffff0000, v65
v_sub_f32 v68, v65, v66
v_mul_f32 v69, v68, v68
s_nop 0
v_add_f32_dpp v68, v68, v68 quad_perm:[1,0,3,2] row_mask:0xf bank_mask:0xf
v_add_f32_dpp v69, v69, v69 quad_perm:[1,0,3,2] row_mask:0xf bank_mask:0xf
s_nop 0
v_add_f32_dpp v68, v68, v68 quad_perm:[2,3,0,1] row_mask:0xf bank_mask:0xf
v_add_f32_dpp v69, v69, v69 quad_perm:[2,3,0,1] row_mask:0xf bank_mask:0xf
s_nop 0
v_add_f32_dpp v68, v68, v68 row_half_mirror row_mask:0xf bank_mask:0xf
v_add_f32_dpp v69, v69, v69 row_half_mirror row_mask:0xf bank_mask:0xf
s_nop 0
v_add_f32_dpp v68, v68, v68 row_ror:8 row_mask:0xf bank_mask:0xf
v_add_f32_dpp v69, v69, v69 row_ror:8 row_mask:0xf bank_mask:0xf
v_mov_b32 v70, v68
s_nop 1
v_permlane16_swap_b32 v68, v70
v_add_f32 v68, v68, v70
v_mov_b32 v70, v69
s_nop 1
v_permlane16_swap_b32 v69, v70
v_add_f32 v69, v69, v70
v_mov_b32 v74, v68
v_mov_b32 v75, v69
s_nop 0
v_permlane32_swap_b32 v68, v74
v_permlane32_swap_b32 v69, v75
v_mov_b32 v76, v68
v_mov_b32 v77, v69
v_mov_b32 v78, v74
v_mov_b32 v79, v75
v_bfi_b32 v76, s87, v4, v76
v_bfi_b32 v77, s87, v5, v77
v_bfi_b32 v78, s87, v6, v78
v_bfi_b32 v79, s87, v7, v79
v_lshlrev_b32 v70, 4, v1
s_mov_b64 exec, 0xff
buffer_store_dwordx4 v[76:79], v70, s[52:55], s60 offen sc1
s_mov_b64 exec, -1
s_cmp_lg_u32 s65, 0
s_cbranch_scc1 L_nostat2_24
v_mov_b32_dpp v72, v65 quad_perm:[0,0,0,0] row_mask:0xf bank_mask:0xf
v_mov_b32_dpp v73, v65 quad_perm:[1,1,1,1] row_mask:0xf bank_mask:0xf
v_mov_b32_dpp v74, v65 quad_perm:[2,2,2,2] row_mask:0xf bank_mask:0xf
v_mov_b32_dpp v75, v65 quad_perm:[3,3,3,3] row_mask:0xf bank_mask:0xf
v_bfi_b32 v72, s87, v4, v72
v_bfi_b32 v73, s87, v5, v73
v_bfi_b32 v74, s87, v6, v74
v_bfi_b32 v75, s87, v7, v75
v_lshrrev_b32 v70, 5, v1
v_lshlrev_b32 v70, 12, v70
v_and_b32 v71, 31, v1
v_lshlrev_b32 v71, 2, v71
v_add_u32 v70, v70, v71
s_lshl_b32 s60, s96, 7
s_add_u32 s60, s60, 0xc000
s_mov_b32 s62, 0x11111111
s_mov_b32 s63, 0x11111111
s_mov_b64 exec, s[62:63]
buffer_store_dwordx4 v[72:75], v70, s[52:55], s60 offen sc1
s_mov_b64 exec, -1
L_nostat2_24:
s_barrier
s_barrier
s_mov_b32 s86, 0
s_sleep 25
L_poll_h4_25:
s_mov_b32 s63, 831488
buffer_load_dwordx4 v[80:83], v24, s[52:55], 0 offen sc1
buffer_load_dwordx4 v[84:87], v24, s[52:55], s63 offen sc1
buffer_load_dwordx4 v[88:91], v29, s[52:55], 0 offen sc1
buffer_load_dwordx4 v[92:95], v29, s[52:55], s63 offen sc1
buffer_load_dwordx4 v[96:99], v27, s[52:55], 0 offen sc1
buffer_load_dwordx4 v[100:103], v27, s[52:55], s63 offen sc1
s_add_u32 s86, s86, 1
s_waitcnt vmcnt(0)
v_xor_b32 v78, v80, v4
v_bitop3_b32 v78, v78, v81, v5 bitop3:0xf6
v_bitop3_b32 v78, v78, v82, v6 bitop3:0xf6
v_bitop3_b32 v78, v78, v83, v7 bitop3:0xf6
v_bitop3_b32 v78, v78, v84, v4 bitop3:0xf6
v_bitop3_b32 v78, v78, v85, v5 bitop3:0xf6
v_bitop3_b32 v78, v78, v86, v6 bitop3:0xf6
v_bitop3_b32 v78, v78, v87, v7 bitop3:0xf6
v_bitop3_b32 v78, v78, v88, v4 bitop3:0xf6
v_bitop3_b32 v78, v78, v89, v5 bitop3:0xf6
v_bitop3_b32 v78, v78, v90, v6 bitop3:0xf6
v_bitop3_b32 v78, v78, v91, v7 bitop3:0xf6
v_bitop3_b32 v78, v78, v92, v4 bitop3:0xf6
v_bitop3_b32 v78, v78, v93, v5 bitop3:0xf6
v_bitop3_b32 v78, v78, v94, v6 bitop3:0xf6
v_bitop3_b32 v78, v78, v95, v7 bitop3:0xf6
v_bitop3_b32 v78, v78, v96, v4 bitop3:0xf6
v_bitop3_b32 v78, v78, v97, v5 bitop3:0xf6
v_bitop3_b32 v78, v78, v98, v6 bitop3:0xf6
v_bitop3_b32 v78, v78, v99, v7 bitop3:0xf6
v_bitop3_b32 v78, v78, v100, v4 bitop3:0xf6
v_bitop3_b32 v78, v78, v101, v5 bitop3:0xf6
v_bitop3_b32 v78, v78, v102, v6 bitop3:0xf6
v_bitop3_b32 v78, v78, v103, v7 bitop3:0xf6
v_and_b32 v78, s87, v78
v_cmp_ne_u32 vcc, 0, v78
s_cbranch_vccz L_pdone_h4_26
s_cmp_gt_u32 s86, 200000
s_cbranch_scc1 L_pdone_h4_26
s_branch L_poll_h4_25
L_pdone_h4_26:
s_cmp_eq_u32 s38, 1
s_cselect_b64 s[60:61], -1, 0
v_cndmask_b32 v96, v96, v98, s[60:61]
v_cndmask_b32 v97, v97, v99, s[60:61]
v_cndmask_b32 v100, v100, v102, s[60:61]
v_cndmask_b32 v101, v101, v103, s[60:61]
v_add_f32 v96, v96, v100
v_add_f32 v97, v97, v101
v_add_f32 v80, v80, v84
v_add_f32 v88, v88, v92
v_add_f32 v81, v81, v85
v_add_f32 v89, v89, v93
v_add_f32 v82, v82, v86
v_add_f32 v90, v90, v94
v_add_f32 v83, v83, v87
v_add_f32 v91, v91, v95
v_mov_b32 v98, v96
s_nop 1
v_permlane16_swap_b32 v96, v98
v_add_f32 v96, v96, v98
v_mov_b32 v98, v96
s_nop 1
v_permlane32_swap_b32 v96, v98
v_add_f32 v96, v96, v98
v_mov_b32 v99, v97
s_nop 1
v_permlane16_swap_b32 v97, v99
v_add_f32 v97, v97, v99
v_mov_b32 v99, v97
s_nop 1
v_permlane32_swap_b32 v97, v99
v_add_f32 v97, v97, v99
v_permlane32_swap_b32 v80, v81
v_permlane32_swap_b32 v82, v83
v_add_f32 v80, v80, v81
v_add_f32 v82, v82, v83
s_nop 1
v_permlane16_swap_b32 v80, v82
v_add_f32 v80, v80, v82
v_permlane32_swap_b32 v88, v89
v_permlane32_swap_b32 v90, v91
v_add_f32 v88, v88, v89
v_add_f32 v90, v90, v91
s_nop 1
v_permlane16_swap_b32 v88, v90
v_add_f32 v88, v88, v90
v_add_f32_dpp v96, v96, v96 row_ror:8 row_mask:0xf bank_mask:0xf
v_add_f32_dpp v97, v97, v97 row_ror:8 row_mask:0xf bank_mask:0xf
v_add_f32_dpp v80, v80, v80 row_ror:8 row_mask:0xf bank_mask:0xf
v_add_f32_dpp v88, v88, v88 row_ror:8 row_mask:0xf bank_mask:0xf
v_add_f32_dpp v96, v96, v96 row_ror:4 row_mask:0xf bank_mask:0xf
v_add_f32_dpp v97, v97, v97 row_ror:4 row_mask:0xf bank_mask:0xf
v_add_f32_dpp v80, v80, v80 row_ror:4 row_mask:0xf bank_mask:0xf
v_add_f32_dpp v88, v88, v88 row_ror:4 row_mask:0xf bank_mask:0xf
v_mul_f32 v96, 0x3a800000, v96
v_mul_f32 v97, 0x3a800000, v97
v_fma_f32 v97, -v96, v96, v97
v_max_f32 v97, 0, v97
v_add_f32 v96, v96, v55
v_cvt_pk_bf16_f32 v96, v96, v97
v_and_b32 v97, 0xffff0000, v96
v_lshlrev_b32 v96, 16, v96
v_add_f32 v97, 0x3727c5ac, v97
v_cvt_pk_bf16_f32 v97, v97, v97
v_lshlrev_b32 v97, 16, v97
v_sqrt_f32 v97, v97
v_fma_f32 v80, -v96, v88, v80
v_cvt_pk_bf16_f32 v97, v97, v97
v_lshlrev_b32 v97, 16, v97
v_rcp_f32 v97, v97
s_nop 0
v_mul_f32 v80, v80, v97
v_cvt_pk_bf16_f32 v80, v80, v80
v_lshlrev_b32 v80, 16, v80
v_mul_f32 v81, 0xbfb8aa3b, v80
v_exp_f32 v81, v81
s_nop 0
v_add_f32 v81, 1.0, v81
v_rcp_f32 v81, v81
s_nop 0
v_mul_f32 v80, v80, v81
v_cvt_pk_bf16_f32 v80, v80, v80
s_mov_b64 exec, s[26:27]
ds_write_b32 v56, v80 offset:25344
s_mov_b64 exec, -1
s_waitcnt lgkmcnt(0)
s_barrier
s_barrier
s_branch L_final
L_final:
s_cmp_ge_u32 s2, 64
s_cbranch_scc1 L_fin
v_and_b32 v16, 15, v1
v_lshrrev_b32 v17, 4, v1
s_cmp_eq_u32 s3, 7
s_cbranch_scc1 L_final_h
s_lshl_b32 s60, s3, 5
s_lshr_b32 s61, s2, 5
s_add_u32 s60, s60, s61
s_mul_i32 s60, s60, 4352
s_and_b32 s61, s2, 31
s_lshl_b32 s61, s61, 7
s_add_u32 s60, s60, s61
s_add_u32 s60, s60, 0x3b0000
v_lshrrev_b32 v24, 3, v1
v_mul_u32_u24 v24, 8704, v24
v_and_b32 v27, 7, v1
v_lshlrev_b32 v27, 4, v27
v_add_u32 v24, v24, v27
v_add_u32 v24, s60, v24
v_and_b32 v25, 1, v17
v_lshlrev_b32 v25, 1, v25
v_lshrrev_b32 v26, 1, v17
v_or_b32 v25, v25, v26
v_lshlrev_b32 v26, 5, v25
v_lshlrev_b32 v27, 3, v27
v_add_u32 v26, v26, v27
s_lshl_b32 s60, s3, 2
v_add_u32 v26, s60, v26
s_mov_b32 s86, 0
s_sleep 20
L_poll_h5_27:
buffer_load_dwordx4 v[80:83], v24, s[52:55], 0 offen sc1
s_mov_b32 s63, 69632
buffer_load_dwordx4 v[84:87], v24, s[52:55], s63 offen sc1
s_add_u32 s86, s86, 1
s_waitcnt vmcnt(0)
v_xor_b32 v78, v80, v4
v_bitop3_b32 v78, v78, v81, v5 bitop3:0xf6
v_bitop3_b32 v78, v78, v82, v6 bitop3:0xf6
v_bitop3_b32 v78, v78, v83, v7 bitop3:0xf6
v_bitop3_b32 v78, v78, v84, v4 bitop3:0xf6
v_bitop3_b32 v78, v78, v85, v5 bitop3:0xf6
v_bitop3_b32 v78, v78, v86, v6 bitop3:0xf6
v_bitop3_b32 v78, v78, v87, v7 bitop3:0xf6
v_and_b32 v78, s87, v78
v_cmp_ne_u32 vcc, 0, v78
s_cbranch_vccz L_pdone_h5_28
s_cmp_gt_u32 s86, 200000
s_cbranch_scc1 L_pdone_h5_28
s_branch L_poll_h5_27
L_pdone_h5_28:
v_add_f32 v80, v80, v84
v_add_f32 v81, v81, v85
v_add_f32 v82, v82, v86
v_add_f32 v83, v83, v87
v_permlane32_swap_b32 v80, v81
s_nop 0
v_permlane32_swap_b32 v82, v83
v_add_f32 v80, v80, v81
v_add_f32 v82, v82, v83
s_nop 1
v_permlane16_swap_b32 v80, v82
v_add_f32 v80, v80, v82
s_nop 1
v_add_f32_dpp v80, v80, v80 row_ror:8 row_mask:0xf bank_mask:0xf
s_mov_b32 s60, 0x00ff00ff
s_mov_b32 s61, 0x00ff00ff
s_mov_b64 exec, s[60:61]
ds_write_b32 v26, v80 offset:0
s_mov_b64 exec, -1
s_waitcnt lgkmcnt(0)
s_barrier
s_branch L_fin
L_final_h:
v_lshrrev_b32 v24, 2, v1
v_lshlrev_b32 v24, 12, v24
v_and_b32 v25, 3, v1
v_lshlrev_b32 v25, 4, v25
v_add_u32 v24, v24, v25
s_lshl_b32 s60, s2, 6
s_add_u32 s60, s60, 0xc000
v_add_u32 v24, s60, v24
s_mov_b32 s86, 0
s_mov_b64 exec, 0xff
L_poll_hb_29:
buffer_load_dwordx4 v[80:83], v24, s[52:55], 0 offen sc1
s_add_u32 s86, s86, 1
s_waitcnt vmcnt(0)
v_xor_b32 v78, v80, v4
v_bitop3_b32 v78, v78, v81, v5 bitop3:0xf6
v_bitop3_b32 v78, v78, v82, v6 bitop3:0xf6
v_bitop3_b32 v78, v78, v83, v7 bitop3:0xf6
v_and_b32 v78, s87, v78
v_cmp_ne_u32 vcc, 0, v78
s_cbranch_vccz L_pdone_hb_30
s_cmp_gt_u32 s86, 200000
s_cbranch_scc1 L_pdone_hb_30
s_branch L_poll_hb_29
L_pdone_hb_30:
s_mov_b64 exec, -1
s_mov_b32 s40, s32
s_mov_b32 s41, s33
s_mov_b32 s42, 0x1000
s_mov_b32 s43, 0x20000
s_not_b32 s60, s87
v_and_b32 v80, s60, v80
v_and_b32 v81, s60, v81
v_and_b32 v82, s60, v82
v_and_b32 v83, s60, v83
v_lshlrev_b32 v25, 4, v1
s_mov_b64 exec, 0xff
ds_write_b128 v25, v[80:83] offset:25728
s_mov_b64 exec, -1
v_lshlrev_b32 v25, 2, v1
ds_read_b32 v84, v25 offset:25728
v_lshlrev_b32 v25, 5, v1
v_lshrrev_b32 v26, 4, v1
v_lshlrev_b32 v26, 11, v26
v_and_b32 v27, 15, v1
v_lshlrev_b32 v27, 1, v27
v_add_u32 v26, v26, v27
s_lshl_b32 s60, s2, 5
v_add_u32 v26, s60, v26
s_waitcnt lgkmcnt(0)
s_barrier
s_mov_b32 exec_hi, 0
ds_read_b128 v[88:91], v25 offset:0
ds_read_b128 v[92:95], v25 offset:16
s_waitcnt lgkmcnt(0)
v_add_f32 v88, v88, v89
v_add_f32 v90, v90, v91
v_add_f32 v92, v92, v93
v_add_f32 v94, v94, v95
v_add_f32 v88, v88, v90
v_add_f32 v92, v92, v94
v_add_f32 v88, v88, v92
v_cvt_pk_bf16_f32 v88, v88, v88
v_lshlrev_b32 v88, 16, v88
v_add_f32 v88, v88, v84
v_cvt_pk_bf16_f32 v88, v88, v88
s_nop 1
v_mov_b32_dpp v89, v88 quad_perm:[1,0,3,2] row_mask:0xf bank_mask:0xf
v_and_b32 v88, 0xffff, v88
v_and_b32 v89, 0xffff0000, v89
v_or_b32 v88, v88, v89
s_mov_b32 s60, 0x55555555
s_mov_b32 exec_lo, s60
buffer_store_dword v88, v26, s[40:43], 0 offen
s_cmp_lg_u32 s2, 0
s_cbranch_scc1 L_final_noe
s_mov_b64 exec, 1
v_mov_b32 v24, s80
v_mov_b32 v25, 0
buffer_store_dword v24, v25, s[52:55], 0 offen sc1
L_final_noe:
s_mov_b64 exec, -1
L_fin:
s_waitcnt vmcnt(0)
L_end:
s_endpgm
L_code_end:
.section .rodata,"a"
.p2align 6
.amdhsa_kernel sequential_preLN__gqa_block_cached__dense_activation_silu__decode_kernel
  .amdhsa_next_free_vgpr 256
  .amdhsa_next_free_sgpr 102
  .amdhsa_accum_offset 256
  .amdhsa_group_segment_fixed_size 0
  .amdhsa_kernarg_size 88
  .amdhsa_user_sgpr_count 2
  .amdhsa_user_sgpr_kernarg_segment_ptr 1
  .amdhsa_system_sgpr_workgroup_id_x 1
  .amdhsa_float_denorm_mode_32 3
.end_amdhsa_kernel
```
